```python
import torch

def _softmax(x, axis=-1):
    return torch.softmax(x, dim=axis)
def _gelu(x):
    return torch.nn.functional.gelu(x, approximate="tanh")
def _silu(x):
    return torch.nn.functional.silu(x)
def _sigmoid(x):
    return torch.sigmoid(x)
def _layernorm(x, axis=-1, eps=1e-5):
    m = x.mean(dim=axis, keepdim=True)
    v = x.var(dim=axis, keepdim=True, unbiased=False)
    return (x - m) / torch.sqrt(v + eps)
def _scatter_add(tgt, idx, src, axis=0):
    return tgt.clone().index_add_(axis, idx, src)
def _segment_sum(src, seg, n):
    out = torch.zeros((n,) + src.shape[1:], dtype=src.dtype)
    return out.index_add_(0, seg, src)
def _pad(x, pw):
    flat = tuple(v for pair in reversed(pw) for v in pair)
    return torch.nn.functional.pad(x, flat)

kernel_name = 'gated_mix__ssm_conv_s5__linear_kernel_hedgehog__prompt'

def setup_inputs():

    _w = (lambda a: (lambda t: t.to(torch.bfloat16) if t.is_floating_point() else t)(torch.as_tensor(a)))
    def _A_setup():
        B, S, D = 1, 2048, 576
        P = D
        Lambda_re = -0.5 * (lambda _x: torch.exp(torch.as_tensor(_x)))((lambda *s: torch.randn(*s, dtype=torch.bfloat16) * 0.8)(P))
        Lambda_im = (lambda *s: torch.randn(*s, dtype=torch.bfloat16) * 0.8)(P) * 1.0
        B_re = (lambda *s: torch.randn(*s, dtype=torch.bfloat16) * 0.8)(P, D) * (D ** -0.5)
        B_im = (lambda *s: torch.randn(*s, dtype=torch.bfloat16) * 0.8)(P, D) * (D ** -0.5)
        C_re = (lambda *s: torch.randn(*s, dtype=torch.bfloat16) * 0.8)(D, P) * (P ** -0.5)
        C_im = (lambda *s: torch.randn(*s, dtype=torch.bfloat16) * 0.8)(D, P) * (P ** -0.5)
        log_dt = (lambda *s: torch.randn(*s, dtype=torch.bfloat16) * 0.8)(P) * 0.3 - 2.0
        Dskip = (lambda *s: torch.randn(*s, dtype=torch.bfloat16) * 0.8)(D)
        return {
            "x": _w((lambda *s: torch.randn(*s, dtype=torch.bfloat16) * 0.05)(B, S, D)),
            "Lambda_re": _w(Lambda_re),
            "Lambda_im": _w(Lambda_im),
            "B_re": _w(B_re),
            "B_im": _w(B_im),
            "C_re": _w(C_re),
            "C_im": _w(C_im),
            "log_dt": _w(log_dt),
            "Dskip": _w(Dskip),
        }
    _A_in = _A_setup()

    def _B_setup():
        B, S, D, H = 1, 2048, 576, 32
        Dh = D // H
        return {
            "x": _w((lambda *s: torch.randn(*s, dtype=torch.bfloat16) * 0.05)(B, S, D)),
            "wqkv": _w((lambda *s: torch.randn(*s, dtype=torch.bfloat16) * 1.6)(D, 3 * D)),
            "w_phi": _w((lambda *s: torch.randn(*s, dtype=torch.bfloat16) * 1.6)(H, Dh, Dh) * (Dh ** -0.5)),
            "wo": _w((lambda *s: torch.randn(*s, dtype=torch.bfloat16) * 0.05)(D, D)),
        }
    _B_in = _B_setup()

    return {
        "A_x": _A_in["x"],
        "A_Lambda_re": _A_in["Lambda_re"],
        "A_Lambda_im": _A_in["Lambda_im"],
        "A_B_re": _A_in["B_re"],
        "A_B_im": _A_in["B_im"],
        "A_C_re": _A_in["C_re"],
        "A_C_im": _A_in["C_im"],
        "A_log_dt": _A_in["log_dt"],
        "A_Dskip": _A_in["Dskip"],
        "B_x": _B_in["x"],
        "B_wqkv": _B_in["wqkv"],
        "B_w_phi": _B_in["w_phi"],
        "B_wo": _B_in["wo"],
        "gate_w": _w((lambda *s: torch.randn(*s, dtype=torch.bfloat16) * 0.05)(576) * 16.0),
    }

def reference(A_x, A_Lambda_re, A_Lambda_im, A_B_re, A_B_im, A_C_re, A_C_im, A_log_dt, A_Dskip, B_x, B_wqkv, B_w_phi, B_wo, gate_w):
    def _A_ref(x, Lambda_re, Lambda_im, B_re, B_im, C_re, C_im, log_dt, Dskip):
        Bsz, L, H = x.shape
        Lam = Lambda_re + 1j * Lambda_im
        Bmat = B_re + 1j * B_im
        Cmat = C_re + 1j * C_im
        dt = torch.exp(log_dt)
        Lam_bar = torch.exp(dt * Lam)
        B_bar = ((Lam_bar - 1.0) / Lam)[:, None] * Bmat
        Bu = torch.einsum("bld,pd->blp", x + 0j, B_bar)
        h = torch.zeros_like(Bu[:, 0, :])
        hs = []
        for t in range(L):
            h = Lam_bar[None, :] * h + Bu[:, t, :]
            hs.append(h)
        hseq = torch.stack(hs, 1)
        y = 2.0 * torch.einsum("blp,dp->bld", hseq, Cmat).real + x * Dskip[None, None, :]
        return y

    def _B_ref(x, wqkv, w_phi, wo):
        B, S, D = x.shape
        H = 32; Dh = D // H
        qkv = (lambda x, *d: x.permute(*d))((x @ wqkv).reshape(B, S, 3, H, Dh), 2, 0, 3, 1, 4)
        q, k, v = qkv[0], qkv[1], qkv[2]
        pq = torch.einsum("bhsd,hdf->bhsf", q, w_phi)
        pk = torch.einsum("bhsd,hdf->bhsf", k, w_phi)
        phi_q = torch.concatenate([_softmax(pq, axis=-1), _softmax(-pq, axis=-1)], axis=-1)
        phi_k = torch.concatenate([_softmax(pk, axis=-1), _softmax(-pk, axis=-1)], axis=-1)
        kv = torch.einsum("bhsf,bhsd->bhfd", phi_k, v)
        z  = torch.einsum("bhsf->bhf", phi_k)
        num = torch.einsum("bhqf,bhfd->bhqd", phi_q, kv)
        den = torch.einsum("bhqf,bhf->bhq", phi_q, z)[..., None] + 1e-6
        o = num / den
        return (lambda x, *d: x.permute(*d))(o, 0, 2, 1, 3).reshape(B, S, D) @ wo

    x = A_x
    g = _sigmoid((x * gate_w).sum(-1, keepdims=True))
    a = _A_ref(x, A_Lambda_re, A_Lambda_im, A_B_re, A_B_im, A_C_re, A_C_im, A_log_dt, A_Dskip)
    b = _B_ref(x, B_wqkv, B_w_phi, B_wo)
    return g * a + (1 - g) * b
```

```asm
; @launch grid=(256,1,1) block=(512,1,1) lds=163840
.amdgcn_target "amdgcn-amd-amdhsa--gfx950"
.text
.globl gated_mix__ssm_conv_s5__linear_kernel_hedgehog__prompt_kernel
.p2align 8
.type gated_mix__ssm_conv_s5__linear_kernel_hedgehog__prompt_kernel,@function
gated_mix__ssm_conv_s5__linear_kernel_hedgehog__prompt_kernel:
    s_load_dwordx16 s[24:39], s[0:1], 64
    s_load_dwordx16 s[8:23], s[0:1], 0
    s_load_dwordx2 s[40:41], s[0:1], 128
    s_cmp_ge_u32 s2, 256
    s_cbranch_scc1 L_end
    v_readfirstlane_b32 s3, v0
    v_and_b32 v0, 63, v0
    v_lshrrev_b32 v4, 3, v0
    v_and_b32 v5, 7, v0
    v_lshlrev_b32 v1, 4, v0
    s_lshr_b32 s3, s3, 6
    s_and_b32 s4, s3, 3
    s_cmp_lt_u32 s3, 4
    s_cbranch_scc1 L_S0
    s_setprio 1
    s_and_b32 s60, s2, 7
    s_lshr_b32 s61, s2, 3
    s_lshr_b32 s63, s61, 2
    s_and_b32 s64, s61, 3
    s_and_b32 s62, s60, 4
    s_lshl_b32 s62, s62, 1
    s_add_u32 s5, s62, s63
    s_and_b32 s62, s60, 3
    s_lshl_b32 s62, s62, 2
    s_add_u32 s6, s62, s64
    v_lshrrev_b32 v3, 1, v4
    v_xor_b32 v3, v5, v3
    v_lshlrev_b32 v3, 4, v3
    s_lshl_b32 s62, s5, 7
    s_lshl_b32 s63, s4, 5
    s_add_u32 s62, s62, s63
    v_add_u32 v2, s62, v4
    v_mul_u32_u24 v2, 1152, v2
    v_add_u32 v20, v2, v3
    v_xor_b32 v6, 64, v3
    v_add_u32 v6, 8192, v6
    v_add_u32 v21, v2, v6
    v_xor_b32 v6, 32, v3
    v_add_u32 v6, 16384, v6
    v_add_u32 v22, v2, v6
    v_xor_b32 v6, 96, v3
    v_add_u32 v6, 24576, v6
    v_add_u32 v23, v2, v6
    s_lshl_b32 s48, s4, 12
    s_waitcnt lgkmcnt(0)
    s_mov_b32 s10, 2359296
    s_mov_b32 s11, 0x20000
    s_add_u32 m0, s48, 131968
    s_movk_i32 s70, 0
    buffer_load_dwordx4 v20, s[8:11], s70 offen offset:0 lds
    buffer_load_dwordx4 v21, s[8:11], s70 offen offset:1024 lds
    buffer_load_dwordx4 v22, s[8:11], s70 offen offset:2048 lds
    buffer_load_dwordx4 v23, s[8:11], s70 offen offset:3072 lds
    s_branch L_A0b
L_S0:
    s_setprio 2
    s_memrealtime s[72:73]
    s_mul_i32 s60, s2, 7282
    s_lshr_b32 s60, s60, 16
    s_mul_i32 s61, s60, 9
    s_sub_u32 s46, s2, s61
    s_lshl_b32 s60, s60, 2
    s_add_u32 s47, s60, s4
    s_mul_i32 s48, s47, 1821
    s_lshr_b32 s48, s48, 16
    s_mul_i32 s49, s48, 36
    s_sub_u32 s49, s47, s49
    s_mul_i32 s60, s49, 55296
    s_mul_i32 s61, s48, 1152
    s_add_u32 s60, s60, s61
    s_lshl_b32 s61, s46, 7
    s_add_u32 s60, s60, s61
    s_cmp_lt_u32 s48, 3
    s_cselect_b32 s60, s60, 1073741824
    s_add_u32 s61, s60, 26624
    v_mul_u32_u24 v6, 3456, v4
    v_lshl_add_u32 v6, v5, 4, v6
    s_lshl_b32 s50, s4, 11
    s_mov_b32 m0, s50
    s_waitcnt lgkmcnt(0)
    s_mov_b32 s30, 1990656
    s_mov_b32 s31, 0x20000
    buffer_load_dwordx4 v6, s[28:31], s60 offen lds
    buffer_load_dwordx4 v6, s[28:31], s61 offen offset:1024 lds
    s_cmp_lg_u32 s47, 112
    s_cbranch_scc1 L_notag
    s_cmp_lg_u32 s2, 255
    s_cbranch_scc1 L_notag
    s_bitset1_b32 s73, 31
    v_mov_b32 v6, 0
    v_mov_b32 v8, s72
    v_mov_b32 v9, s73
    s_mov_b64 exec, 1
    global_store_dwordx2 v6, v[8:9], s[38:39] sc1
    s_mov_b64 exec, -1
L_notag:
    s_getpc_b64 s[62:63]
    s_lshl_b32 s64, s3, 5
    s_lshr_b32 s65, s2, 3
    s_add_u32 s64, s64, s65
    s_lshl_b32 s64, s64, 6
    s_add_u32 s62, s62, s64
    s_addc_u32 s63, s63, 0
    s_load_dword s71, s[62:63], 0
    s_load_dword s71, s[62:63], 16384
    s_load_dword s71, s[62:63], 32768
    s_branch L_S1
L_A0b:
    s_getpc_b64 s[62:63]
    s_lshl_b32 s64, s3, 5
    s_lshr_b32 s65, s2, 3
    s_add_u32 s64, s64, s65
    s_lshl_b32 s64, s64, 6
    s_add_u32 s62, s62, s64
    s_addc_u32 s63, s63, 0
    s_load_dword s71, s[62:63], 0
    s_load_dword s71, s[62:63], 16384
    s_load_dword s71, s[62:63], 32768
    s_mul_i32 s62, s6, 36
    s_lshl_b32 s63, s4, 3
    s_add_u32 s63, s62, s63
    v_lshrrev_b32 v28, 1, v4
    v_add_u32 v28, s63, v28
    v_mul_u32_u24 v28, 1152, v28
    s_and_b32 s64, s4, 1
    s_lshl_b32 s64, s64, 5
    v_xor_b32 v29, s64, v3
    v_add_u32 v6, v28, v29
    v_xor_b32 v29, 64, v29
    v_add_u32 v29, 3584, v29
    v_add_u32 v8, v28, v29
    s_add_u32 s62, s62, 32
    s_add_u32 s62, s62, s4
    s_mul_i32 s62, s62, 1152
    v_xor_b32 v28, s4, v5
    v_lshlrev_b32 v28, 4, v28
    v_add_u32 v28, s62, v28
    v_cmp_eq_u32 s[66:67], 2, v4
    v_and_b32 v30, 1, v4
    v_cmp_eq_u32 vcc, 1, v30
    v_xor_b32 v29, 4, v5
    v_lshlrev_b32 v29, 4, v29
    v_cndmask_b32 v10, v28, v29, s[66:67]
    s_mov_b32 s69, 0xffff
    s_cmp_eq_u32 s4, 3
    s_cselect_b32 s68, 0xffffff, s69
    s_mov_b32 s69, 0
    s_lshl_b32 s49, s4, 11
    s_lshl_b32 s50, s4, 8
    v_mov_b32 v7, 0
    v_mov_b32 v9, 0
    v_mov_b32 v11, 0
    v_mov_b32 v28, s14
    v_mov_b32 v29, s15
    v_mov_b32 v30, s16
    v_mov_b32 v31, s17
    v_cndmask_b32 v28, v28, v30, vcc
    v_cndmask_b32 v29, v29, v31, vcc
    v_lshl_add_u64 v[6:7], v[6:7], 0, v[28:29]
    v_lshl_add_u64 v[8:9], v[8:9], 0, v[28:29]
    v_mov_b32 v30, s34
    v_mov_b32 v31, s35
    v_cndmask_b32 v28, v28, v30, s[66:67]
    v_cndmask_b32 v29, v29, v31, s[66:67]
    v_lshl_add_u64 v[10:11], v[10:11], 0, v[28:29]
    s_add_u32 m0, s49, 148352
    s_nop 0
    global_load_lds_dwordx4 v[6:7], off offset:0
    global_load_lds_dwordx4 v[8:9], off offset:1024
    s_add_u32 m0, s50, 156544
    s_mov_b64 exec, s[68:69]
    global_load_lds_dwordx4 v[10:11], off offset:0
    s_mov_b64 exec, -1
    s_add_u32 m0, s48, 54784
    s_movk_i32 s70, 128
    buffer_load_dwordx4 v20, s[8:11], s70 offen offset:0 lds
    buffer_load_dwordx4 v21, s[8:11], s70 offen offset:1024 lds
    buffer_load_dwordx4 v22, s[8:11], s70 offen offset:2048 lds
    buffer_load_dwordx4 v23, s[8:11], s70 offen offset:3072 lds
    s_add_u32 m0, s49, 71040
    s_nop 0
    global_load_lds_dwordx4 v[6:7], off offset:128
    global_load_lds_dwordx4 v[8:9], off offset:1152
    s_add_u32 m0, s50, 79232
    s_mov_b64 exec, s[68:69]
    global_load_lds_dwordx4 v[10:11], off offset:128
    s_mov_b64 exec, -1
    s_branch L_A1
L_S1:
    s_mov_b32 s42, 268435456
    s_mov_b32 s43, 0x20000
    v_and_b32 v10, 3, v0
    s_lshl_b32 s74, s46, 6
    v_add_u32 v9, s74, v0
    v_mul_u32_u24 v22, 1821, v9
    v_lshrrev_b32 v22, 16, v22
    v_mul_u32_u24 v11, 36, v22
    v_sub_u32 v11, v9, v11
    s_lshr_b32 s74, s49, 1
    s_and_b32 s62, s49, 1
    s_lshl_b32 s62, s62, 9
    s_mul_i32 s63, s74, 5120
    s_add_u32 s63, s63, s62
    s_add_u32 s63, s63, 0
    s_lshl_b32 s64, s74, 11
    s_add_u32 s64, s64, s62
    s_add_u32 s64, s64, 92160
    s_lshl_b32 s74, s48, 6
    s_add_u32 s74, s74, 3584
    s_add_u32 s74, s74, s63
    s_mov_b32 s62, 129024
    v_mul_lo_u32 v22, s62, v22
    v_lshl_add_u32 v23, v11, 4, v22
    v_add_u32 v23, s74, v23
    s_cmp_eq_u32 s48, 2
    s_cselect_b32 s74, 2048, 0
    s_add_u32 s63, s63, s74
    s_cmp_eq_u32 s48, 0
    s_cselect_b32 s63, s64, s63
    v_lshrrev_b32 v20, 4, v11
    v_lshlrev_b32 v20, 10, v20
    v_and_b32 v21, 15, v11
    v_lshl_add_u32 v20, v21, 4, v20
    v_add3_u32 v22, v22, v20, s63
    v_cmp_le_u32 vcc, 32, v11
    s_cmp_lt_u32 s48, 3
    s_cselect_b32 s74, 0, 1073741824
    v_cndmask_b32 v20, v22, v23, vcc
    v_and_b32 v4, 15, v0
    v_lshrrev_b32 v5, 4, v0
    v_bfe_u32 v9, v0, 2, 2
    v_lshlrev_b32 v9, 7, v9
    v_lshl_add_u32 v9, v5, 5, v9
    v_lshl_add_u32 v9, v10, 3, v9
    v_add_u32 v9, s50, v9
    v_bfe_u32 v21, v4, 1, 1
    v_lshrrev_b32 v22, 3, v4
    v_lshl_or_b32 v21, v22, 1, v21
    v_and_b32 v22, 4, v4
    v_or_b32 v21, v21, v22
    v_xor_b32 v21, v21, v5
    v_lshlrev_b32 v21, 4, v21
    v_lshrrev_b32 v22, 2, v4
    v_lshl_add_u32 v22, v22, 3, v10
    v_lshlrev_b32 v22, 7, v22
    s_lshl_b32 s61, s4, 12
    s_add_u32 s61, s61, 106240
    v_add_u32 v22, s61, v22
    v_xor_b32 v23, 0, v21
    v_add_u32 v23, 0, v23
    v_add_u32 v136, v22, v23
    v_xor_b32 v23, 64, v21
    v_add_u32 v23, 0, v23
    v_add_u32 v137, v22, v23
    v_xor_b32 v23, 32, v21
    v_add_u32 v23, 512, v23
    v_add_u32 v138, v22, v23
    v_xor_b32 v23, 96, v21
    v_add_u32 v23, 512, v23
    v_add_u32 v139, v22, v23
    v_lshrrev_b32 v21, 1, v4
    v_xor_b32 v21, v21, v5
    v_lshlrev_b32 v21, 4, v21
    v_lshlrev_b32 v22, 7, v4
    v_add_u32 v22, 122624, v22
    v_xor_b32 v23, 0, v21
    v_add_u32 v140, v22, v23
    v_xor_b32 v23, 64, v21
    v_add_u32 v141, v22, v23
    v_xor_b32 v23, 32, v21
    v_add_u32 v142, v22, v23
    v_xor_b32 v23, 96, v21
    v_add_u32 v143, v22, v23
    s_and_b32 s60, s2, 7
    s_lshr_b32 s61, s2, 3
    s_lshr_b32 s63, s61, 2
    s_and_b32 s64, s61, 3
    s_and_b32 s62, s60, 4
    s_lshl_b32 s62, s62, 1
    s_add_u32 s5, s62, s63
    s_and_b32 s62, s60, 3
    s_lshl_b32 s62, s62, 2
    s_add_u32 s6, s62, s64
    s_mul_i32 s61, s6, 72
    v_min_u32 v11, 35, v0
    v_lshl_add_u32 v11, v11, 1, s61
    s_waitcnt vmcnt(0)
    ds_read_b64_tr_b16 v[24:25], v9 offset:0
    ds_read_b64_tr_b16 v[26:27], v9 offset:512
    ds_read_b64_tr_b16 v[28:29], v9 offset:1024
    ds_read_b64_tr_b16 v[30:31], v9 offset:1536
    s_waitcnt lgkmcnt(2)
    buffer_store_dwordx4 v[24:27], v20, s[40:43], s74 offen offset:0 sc1
    s_waitcnt lgkmcnt(0)
    buffer_store_dwordx4 v[28:31], v20, s[40:43], s74 offen offset:256 sc1
    global_load_ushort v98, v11, s[10:11]
    global_load_ushort v99, v11, s[12:13]
    global_load_ushort v100, v11, s[22:23]
    s_lshl_b32 s61, s4, 2
    s_add_u32 s61, s61, 163792
    v_mov_b32 v3, 0x7fff0000
    v_writelane_b32 v3, s61, 0
    v_mov_b32 v2, 163776
    s_branch L_S2
L_A1:
    s_mov_b32 s42, 268435456
    s_mov_b32 s43, 0x20000
    v_and_b32 v14, 15, v0
    v_lshrrev_b32 v15, 4, v0
    v_lshrrev_b32 v26, 1, v14
    v_xor_b32 v26, v15, v26
    v_lshlrev_b32 v26, 4, v26
    v_lshlrev_b32 v28, 7, v14
    s_add_u32 s62, s48, 54784
    v_add_u32 v28, s62, v28
    v_xor_b32 v29, 0, v26
    v_add_u32 v29, 0, v29
    v_add_u32 v64, v28, v29
    v_add_u32 v68, 51456, v64
    v_xor_b32 v29, 64, v26
    v_add_u32 v29, 0, v29
    v_add_u32 v65, v28, v29
    v_add_u32 v69, 51456, v65
    v_xor_b32 v29, 32, v26
    v_add_u32 v29, 2048, v29
    v_add_u32 v66, v28, v29
    v_add_u32 v70, 51456, v66
    v_xor_b32 v29, 96, v26
    v_add_u32 v29, 2048, v29
    v_add_u32 v67, v28, v29
    v_add_u32 v71, 51456, v67
    s_lshl_b32 s61, s4, 2
    s_add_u32 s61, s61, 163776
    v_mov_b32 v19, 0x7fff0000
    v_writelane_b32 v19, s61, 0
    v_mov_b32 v18, 163776
    v_mov_b32 v28, 0
    ds_write_b32 v19, v28
    ds_write_b32 v19, v28 offset:16
    s_add_u32 m0, s48, 80512
    s_movk_i32 s70, 256
    buffer_load_dwordx4 v20, s[8:11], s70 offen offset:0 lds
    buffer_load_dwordx4 v21, s[8:11], s70 offen offset:1024 lds
    s_mul_i32 s60, s2, 7282
    s_lshr_b32 s60, s60, 16
    s_mul_i32 s61, s60, 9
    s_sub_u32 s46, s2, s61
    s_lshl_b32 s60, s60, 2
    s_add_u32 s47, s60, s4
    s_mov_b64 s[16:17], s[18:19]
    s_mov_b32 s18, 663552
    s_mov_b32 s19, 0x20000
    s_mov_b32 s22, 663552
    s_mov_b32 s23, 0x20000
    s_mov_b32 s34, 663552
    s_mov_b32 s35, 0x20000
    s_lshr_b32 s61, s47, 1
    s_mul_i32 s61, s61, 18
    s_and_b32 s62, s47, 1
    s_lshl_b32 s62, s62, 3
    s_add_u32 s61, s61, s62
    v_add_u32 v26, s61, v4
    s_sub_u32 s61, s47, 64
    s_lshr_b32 s62, s61, 2
    s_lshl_b32 s62, s62, 3
    s_and_b32 s61, s61, 3
    s_add_u32 s61, s61, s62
    s_mul_i32 s61, s61, 36
    s_add_u32 s61, s61, 16
    v_lshrrev_b32 v27, 2, v4
    v_mul_u32_u24 v27, 144, v27
    v_bfe_u32 v28, v4, 1, 1
    v_mul_u32_u24 v28, 18, v28
    v_and_b32 v29, 1, v4
    v_add3_u32 v27, v27, v28, v29
    v_add_u32 v27, s61, v27
    s_cmp_lt_u32 s47, 64
    s_cselect_b64 vcc, -1, 0
    v_cndmask_b32 v26, v27, v26, vcc
    v_mul_u32_u24 v26, 1152, v26
    v_lshl_add_u32 v56, v5, 4, v26
    s_waitcnt vmcnt(9) lgkmcnt(0)
    s_barrier
    ds_read_b128 v[112:115], v68 offset:25728
    ds_read_b128 v[120:123], v69 offset:25728
    ds_read_b128 v[116:119], v70 offset:25728
    ds_read_b128 v[124:127], v71 offset:25728
    s_add_u32 m0, s48, 80512
    s_movk_i32 s70, 256
    buffer_load_dwordx4 v22, s[8:11], s70 offen offset:2048 lds
    buffer_load_dwordx4 v23, s[8:11], s70 offen offset:3072 lds
    s_add_u32 m0, s49, 96640
    s_nop 0
    global_load_lds_dwordx4 v[6:7], off offset:256
    global_load_lds_dwordx4 v[8:9], off offset:1280
    s_add_u32 m0, s50, 104832
    s_mov_b64 exec, s[68:69]
    global_load_lds_dwordx4 v[10:11], off offset:256
    s_mov_b64 exec, -1
    s_lshl_b32 s61, s46, 7
    s_cmp_lt_u32 s47, 72
    s_cselect_b32 s61, s61, 1073741824
    s_mul_i32 s51, s4, 3072
    s_add_u32 m0, s51, 8192
    s_nop 0
    buffer_load_dwordx4 v56, s[32:35], s61 offen lds
    s_sub_u32 s61, s47, 36
    s_mul_i32 s52, s61, 7282
    s_lshr_b32 s52, s52, 16
    s_mul_i32 s53, s52, 9
    s_sub_u32 s53, s61, s53
    s_lshl_b32 s62, s46, 3
    s_add_u32 s52, s52, s62
    s_mul_i32 s62, s52, 9216
    s_lshl_b32 s63, s53, 7
    s_add_u32 s62, s62, s63
    s_cmp_lt_u32 s61, 72
    s_cselect_b32 s62, s62, 1073741824
    s_cselect_b32 s54, 0, 1073741824
    v_mul_u32_u24 v27, 1152, v4
    v_lshl_add_u32 v27, v5, 4, v27
    s_add_u32 m0, s51, 9216
    s_nop 0
    buffer_load_dwordx4 v27, s[16:19], s62 offen lds
    s_add_u32 m0, s51, 10240
    s_nop 0
    buffer_load_dwordx4 v27, s[20:23], s62 offen lds
    s_add_u32 m0, s48, 106240
    s_movk_i32 s70, 384
    buffer_load_dwordx4 v20, s[8:11], s70 offen offset:0 lds
    buffer_load_dwordx4 v21, s[8:11], s70 offen offset:1024 lds
    s_waitcnt vmcnt(12) lgkmcnt(0)
    s_barrier
    ds_read_b128 v[128:131], v64 offset:0
    ds_read_b128 v[136:139], v65 offset:0
    ds_read_b128 v[132:135], v66 offset:0
    ds_read_b128 v[140:143], v67 offset:0
    s_add_u32 m0, s48, 106240
    s_movk_i32 s70, 384
    buffer_load_dwordx4 v22, s[8:11], s70 offen offset:2048 lds
    buffer_load_dwordx4 v23, s[8:11], s70 offen offset:3072 lds
    s_add_u32 m0, s49, 122240
    s_nop 0
    global_load_lds_dwordx4 v[6:7], off offset:384
    global_load_lds_dwordx4 v[8:9], off offset:1408
    s_add_u32 m0, s50, 130432
    s_mov_b64 exec, s[68:69]
    global_load_lds_dwordx4 v[10:11], off offset:384
    s_mov_b64 exec, -1
    s_mul_i32 s62, s6, 1296
    v_add_u32 v28, s62, v1
    s_add_u32 m0, s49, 24576
    s_nop 0
    global_load_lds_dwordx4 v28, s[30:31]
    s_mov_b64 exec, 0x1ffff
    global_load_lds_dwordx4 v28, s[30:31] offset:1024
    s_mov_b64 exec, -1
    s_add_u32 m0, s48, 131968
    s_movk_i32 s70, 512
    buffer_load_dwordx4 v20, s[8:11], s70 offen offset:0 lds
    buffer_load_dwordx4 v21, s[8:11], s70 offen offset:1024 lds
    s_lshl_b32 s61, s46, 6
    v_add_u32 v26, s61, v0
    v_mul_u32_u24 v27, 911, v26
    v_lshrrev_b32 v27, 16, v27
    v_mul_u32_u24 v28, 72, v27
    v_sub_u32 v28, v26, v28
    s_and_b32 s61, s47, 3
    s_lshl_b32 s62, s61, 8
    s_lshl_b32 s61, s61, 7
    s_add_u32 s61, s61, 3072
    v_lshrrev_b32 v29, 4, v28
    v_lshlrev_b32 v29, 10, v29
    v_and_b32 v30, 15, v28
    v_lshl_add_u32 v29, v30, 4, v29
    v_add_u32 v29, s62, v29
    v_lshl_add_u32 v30, v28, 4, s61
    v_cmp_le_u32 vcc, 64, v28
    s_mov_b32 s61, 248832
    v_mul_lo_u32 v27, s61, v27
    v_cndmask_b32 v29, v29, v30, vcc
    s_lshr_b32 s61, s47, 2
    s_mul_i32 s61, s61, 4608
    s_add_u32 s61, s61, 2230272
    s_cmp_lt_u32 s47, 72
    s_cselect_b32 s61, s61, 1073741824
    v_add3_u32 v52, v27, v29, s61
    s_waitcnt vmcnt(14) lgkmcnt(0)
    s_barrier
    ds_read_b128 v[144:147], v64 offset:25728
    ds_read_b128 v[152:155], v65 offset:25728
    ds_read_b128 v[148:151], v66 offset:25728
    ds_read_b128 v[156:159], v67 offset:25728
    s_add_u32 m0, s48, 131968
    s_movk_i32 s70, 512
    buffer_load_dwordx4 v22, s[8:11], s70 offen offset:2048 lds
    buffer_load_dwordx4 v23, s[8:11], s70 offen offset:3072 lds
    s_add_u32 m0, s49, 147840
    s_nop 0
    global_load_lds_dwordx4 v[6:7], off offset:512
    global_load_lds_dwordx4 v[8:9], off offset:1536
    s_add_u32 m0, s50, 156032
    s_mov_b64 exec, s[68:69]
    global_load_lds_dwordx4 v[10:11], off offset:512
    s_mov_b64 exec, -1
    v_mov_b32 v44, -1
    v_mov_b32 v45, -1
    v_mov_b32 v46, -1
    v_mov_b32 v47, -1
    s_lshl_b32 s61, s6, 4
    s_add_u32 s61, s61, s5
    s_mul_i32 s61, s61, 3200
    s_lshl_b32 s62, s4, 10
    s_add_u32 s61, s61, s62
    s_add_u32 s61, s61, 11296768
    s_cmp_eq_u32 s4, 3
    s_cselect_b64 exec, 0xff, -1
    buffer_store_dwordx4 v[44:47], v1, s[40:43], s61 offen sc1
    s_mov_b64 exec, -1
    s_add_u32 m0, s48, 54784
    s_movk_i32 s70, 640
    buffer_load_dwordx4 v20, s[8:11], s70 offen offset:0 lds
    buffer_load_dwordx4 v21, s[8:11], s70 offen offset:1024 lds
    s_mul_i32 s61, s52, 7282
    s_lshr_b32 s61, s61, 16
    s_mul_i32 s62, s61, 9
    s_sub_u32 s62, s52, s62
    s_mul_i32 s61, s61, 248832
    s_mul_i32 s63, s53, 18432
    s_add_u32 s61, s61, s63
    s_add_u32 s61, s61, 2064384
    s_lshr_b32 s63, s62, 1
    s_lshl_b32 s63, s63, 10
    s_add_u32 s61, s61, s63
    s_and_b32 s63, s62, 1
    s_lshl_b32 s63, s63, 7
    s_add_u32 s61, s61, s63
    s_cmp_lt_u32 s62, 8
    s_cselect_b32 s63, 8, 7
    s_cmp_eq_u32 s54, 0
    s_cselect_b32 s61, s61, 1073741824
    v_and_b32 v26, 3, v4
    v_lshlrev_b32 v26, s63, v26
    v_lshrrev_b32 v27, 2, v4
    v_mul_u32_u24 v27, 4608, v27
    v_lshl_add_u32 v27, v5, 4, v27
    v_add3_u32 v53, v26, v27, s61
    v_bfe_u32 v26, v0, 2, 2
    v_lshlrev_b32 v26, 7, v26
    v_lshl_add_u32 v26, v15, 5, v26
    v_and_b32 v27, 3, v0
    v_lshl_add_u32 v26, v27, 3, v26
    v_add_u32 v54, s51, v26
    v_lshlrev_b32 v26, 7, v5
    v_lshl_add_u32 v26, v4, 3, v26
    v_add_u32 v55, s51, v26
    s_waitcnt vmcnt(12) lgkmcnt(0)
    s_barrier
    ds_read_b128 v[160:163], v68 offset:0
    ds_read_b128 v[168:171], v69 offset:0
    ds_read_b128 v[164:167], v70 offset:0
    ds_read_b128 v[172:175], v71 offset:0
    ds_read_b64_tr_b16 v[32:33], v54 offset:8192
    ds_read_b64_tr_b16 v[34:35], v54 offset:8704
    ds_read_b64 v[36:37], v55 offset:9216
    ds_read_b64 v[38:39], v55 offset:10240
    ds_read_b64 v[40:41], v55 offset:9280
    ds_read_b64 v[42:43], v55 offset:10304
    s_add_u32 m0, s48, 54784
    s_movk_i32 s70, 640
    buffer_load_dwordx4 v22, s[8:11], s70 offen offset:2048 lds
    buffer_load_dwordx4 v23, s[8:11], s70 offen offset:3072 lds
    s_add_u32 m0, s49, 70528
    s_nop 0
    global_load_lds_dwordx4 v[6:7], off offset:640
    global_load_lds_dwordx4 v[8:9], off offset:1664
    s_add_u32 m0, s50, 78720
    s_mov_b64 exec, s[68:69]
    global_load_lds_dwordx4 v[10:11], off offset:640
    s_mov_b64 exec, -1
    s_waitcnt lgkmcnt(0)
    buffer_store_dwordx4 v[32:35], v52, s[40:43], 0 offen sc1
    s_add_u32 m0, s48, 80512
    s_movk_i32 s70, 768
    buffer_load_dwordx4 v20, s[8:11], s70 offen offset:0 lds
    buffer_load_dwordx4 v21, s[8:11], s70 offen offset:1024 lds
    s_lshl_b32 s56, s4, 12
    s_mul_i32 s55, s6, 129024
    s_add_u32 s55, s55, 0
    s_add_u32 s55, s55, s56
    ds_read_b64 v[90:91], v18 offset:32
    s_waitcnt vmcnt(11) lgkmcnt(0)
    s_barrier
    ds_read_b128 v[176:179], v68 offset:25728
    ds_read_b128 v[184:187], v69 offset:25728
    ds_read_b128 v[180:183], v70 offset:25728
    ds_read_b128 v[188:191], v71 offset:25728
    v_readfirstlane_b32 s100, v90
    v_readfirstlane_b32 s101, v91
    s_add_u32 m0, s48, 80512
    s_movk_i32 s70, 768
    buffer_load_dwordx4 v22, s[8:11], s70 offen offset:2048 lds
    buffer_load_dwordx4 v23, s[8:11], s70 offen offset:3072 lds
    s_add_u32 m0, s49, 96128
    s_nop 0
    global_load_lds_dwordx4 v[6:7], off offset:768
    global_load_lds_dwordx4 v[8:9], off offset:1792
    s_add_u32 m0, s50, 104320
    s_mov_b64 exec, s[68:69]
    global_load_lds_dwordx4 v[10:11], off offset:768
    s_mov_b64 exec, -1
    buffer_store_dwordx4 v[36:39], v53, s[40:43], 0 offen sc1
    s_add_u32 m0, s48, 106240
    s_movk_i32 s70, 896
    buffer_load_dwordx4 v20, s[8:11], s70 offen offset:0 lds
    buffer_load_dwordx4 v21, s[8:11], s70 offen offset:1024 lds
    v_bfe_u32 v28, v14, 2, 1
    v_mul_u32_u24 v28, 9, v28
    v_and_b32 v29, 3, v14
    v_add_lshl_u32 v28, v28, v29, 1
    s_lshl_b32 s62, s4, 3
    s_add_u32 s62, s62, s49
    s_add_u32 s62, s62, 24576
    v_add_u32 v28, s62, v28
    v_mul_u32_u24 v29, 144, v15
    v_add_u32 v29, v28, v29
    ds_read_u16 v72, v29 offset:0
    ds_read_u16 v73, v29 offset:36
    ds_read_u16 v74, v29 offset:72
    ds_read_u16 v75, v29 offset:108
    ds_read_u16 v76, v29 offset:576
    ds_read_u16 v77, v29 offset:612
    ds_read_u16 v78, v29 offset:648
    ds_read_u16 v79, v29 offset:684
    ds_read_u16 v80, v28 offset:1152
    ds_read_u16 v81, v28 offset:1188
    ds_read_u16 v82, v28 offset:1224
    ds_read_u16 v83, v28 offset:1260
    s_waitcnt vmcnt(11) lgkmcnt(0)
    s_barrier
    ds_read_b128 v[192:195], v64 offset:0
    ds_read_b128 v[200:203], v65 offset:0
    ds_read_b128 v[196:199], v66 offset:0
    ds_read_b128 v[204:207], v67 offset:0
    s_add_u32 m0, s48, 106240
    s_movk_i32 s70, 896
    buffer_load_dwordx4 v22, s[8:11], s70 offen offset:2048 lds
    buffer_load_dwordx4 v23, s[8:11], s70 offen offset:3072 lds
    s_add_u32 m0, s49, 121728
    s_nop 0
    global_load_lds_dwordx4 v[6:7], off offset:896
    global_load_lds_dwordx4 v[8:9], off offset:1920
    s_add_u32 m0, s50, 129920
    s_mov_b64 exec, s[68:69]
    global_load_lds_dwordx4 v[10:11], off offset:896
    s_mov_b64 exec, -1
    s_mov_b32 s61, 9216
    buffer_store_dwordx4 v[40:43], v53, s[40:43], s61 offen sc1
    s_add_u32 m0, s48, 131968
    s_movk_i32 s70, 1024
    buffer_load_dwordx4 v20, s[8:11], s70 offen offset:0 lds
    buffer_load_dwordx4 v21, s[8:11], s70 offen offset:1024 lds
    v_cmp_gt_u32 s[62:63], 8, v14
    v_cmp_eq_u32 s[66:67], 0, v15
    v_lshl_or_b32 v84, v73, 16, v72
    v_lshl_or_b32 v85, v75, 16, v74
    v_lshl_or_b32 v86, v77, 16, v76
    v_lshl_or_b32 v87, v79, 16, v78
    v_lshl_or_b32 v88, v81, 16, v80
    v_lshl_or_b32 v89, v83, 16, v82
    s_xnor_b64 s[66:67], s[62:63], s[66:67]
    v_cndmask_b32 v84, 0, v84, s[62:63]
    v_cndmask_b32 v85, 0, v85, s[62:63]
    v_cndmask_b32 v86, 0, v86, s[66:67]
    v_cndmask_b32 v87, v87, 0, s[62:63]
    v_cndmask_b32 v88, v88, 0, s[62:63]
    v_cndmask_b32 v89, v89, 0, s[62:63]
    s_cmp_eq_u32 s4, 3
    s_cbranch_scc1 L_nowp
    s_lshl_b32 s62, s4, 10
    s_add_u32 s62, s62, 157696
    v_add_u32 v28, s62, v1
    ds_write_b128 v28, v[84:87]
    s_lshl_b32 s62, s4, 9
    s_add_u32 s62, s62, 160768
    v_lshl_add_u32 v28, v0, 3, s62
    ds_write_b64 v28, v[88:89]
L_nowp:
    s_waitcnt vmcnt(11) lgkmcnt(0)
    s_barrier
    ds_read_b128 v[208:211], v64 offset:25728
    ds_read_b128 v[216:219], v65 offset:25728
    ds_read_b128 v[212:215], v66 offset:25728
    ds_read_b128 v[220:223], v67 offset:25728
    s_add_u32 m0, s48, 131968
    s_movk_i32 s70, 1024
    buffer_load_dwordx4 v22, s[8:11], s70 offen offset:2048 lds
    buffer_load_dwordx4 v23, s[8:11], s70 offen offset:3072 lds
    s_add_u32 m0, s49, 147328
    s_nop 0
    global_load_lds_dwordx4 v[6:7], off offset:1024
    global_load_lds_dwordx4 v[8:9], off offset:2048
    s_add_u32 m0, s50, 155520
    s_mov_b64 exec, s[68:69]
    global_load_lds_dwordx4 v[10:11], off offset:1024
    s_mov_b64 exec, -1
    s_add_u32 m0, s56, 0
    s_nop 0
    buffer_load_dwordx4 v1, s[40:43], s55 offen offset:0 sc1 lds
    buffer_load_dwordx4 v1, s[40:43], s55 offen offset:1024 sc1 lds
    buffer_load_dwordx4 v1, s[40:43], s55 offen offset:2048 sc1 lds
    buffer_load_dwordx4 v1, s[40:43], s55 offen offset:3072 sc1 lds
    s_add_u32 s55, s55, 16384
    s_and_b32 s60, s2, 7
    s_lshr_b32 s61, s2, 3
    s_lshr_b32 s63, s61, 3
    s_lshl_b32 s62, s60, 2
    s_add_u32 s44, s62, s63
    s_and_b32 s45, s61, 7
    v_add_u32 v20, 157696, v1
    v_lshlrev_b32 v23, 3, v0
    v_add_u32 v23, 160768, v23
    s_mul_i32 s62, s4, 9216
    v_mul_u32_u24 v6, 288, v14
    v_add_u32 v6, s62, v6
    v_lshl_add_u32 v12, v15, 3, v6
    v_cmp_eq_u32 s[64:65], 1, v15
    v_cmp_eq_u32 s[66:67], 0, v15
    v_mul_u32_u24 v28, 48, v15
    v_add_u32 v6, v28, v6
    v_cndmask_b32 v28, 4, 0, s[66:67]
    v_add_u32 v13, v12, v28
    s_mov_b32 s68, 1069066811
    s_mov_b32 s69, 3216550459
    v_lshrrev_b32 v28, 2, v0
    v_mul_u32_u24 v28, 288, v28
    v_and_b32 v29, 3, v0
    s_lshr_b32 s62, s4, 1
    s_and_b32 s63, s4, 1
    s_mul_i32 s70, s62, 96
    v_add_u32 v30, 0, v29
    v_min_u32 v30, 9, v30
    v_cmp_lt_u32 s[72:73], 4, v30
    v_lshlrev_b32 v30, 3, v30
    v_add3_u32 v30, v30, v28, s70
    v_cndmask_b32 v31, 0, 8, s[72:73]
    v_add_u32 v7, v30, v31
    v_add_u32 v30, 4, v29
    v_min_u32 v30, 9, v30
    v_cmp_lt_u32 s[72:73], 4, v30
    v_lshlrev_b32 v30, 3, v30
    v_add3_u32 v30, v30, v28, s70
    v_cndmask_b32 v31, 0, 8, s[72:73]
    v_add_u32 v8, v30, v31
    v_add_u32 v30, 8, v29
    v_min_u32 v30, 9, v30
    v_cmp_lt_u32 s[72:73], 4, v30
    v_lshlrev_b32 v30, 3, v30
    s_waitcnt vmcnt(12) lgkmcnt(0)
    s_barrier
    ds_read_b128 v[224:227], v68 offset:0
    ds_read_b128 v[232:235], v69 offset:0
    ds_read_b128 v[228:231], v70 offset:0
    ds_read_b128 v[236:239], v71 offset:0
    s_add_u32 m0, s56, 16384
    s_nop 0
    buffer_load_dwordx4 v1, s[40:43], s55 offen offset:0 sc1 lds
    buffer_load_dwordx4 v1, s[40:43], s55 offen offset:1024 sc1 lds
    buffer_load_dwordx4 v1, s[40:43], s55 offen offset:2048 sc1 lds
    buffer_load_dwordx4 v1, s[40:43], s55 offen offset:3072 sc1 lds
    s_add_u32 s55, s55, 16384
    s_add_u32 m0, s56, 32768
    s_nop 0
    buffer_load_dwordx4 v1, s[40:43], s55 offen offset:0 sc1 lds
    buffer_load_dwordx4 v1, s[40:43], s55 offen offset:1024 sc1 lds
    v_add3_u32 v30, v30, v28, s70
    v_cndmask_b32 v31, 0, 8, s[72:73]
    v_add_u32 v9, v30, v31
    s_mul_i32 s70, s62, 40
    s_add_u32 s70, s70, 192
    v_lshlrev_b32 v30, 3, v29
    s_sub_u32 s74, s63, 1
    s_mov_b32 s75, s74
    v_cndmask_b32 v30, 32, v30, s[74:75]
    v_add3_u32 v10, v28, v30, s70
    v_lshlrev_b32 v31, 5, v15
    v_cmp_gt_u32 s[72:73], 4, v14
    v_lshl_add_u32 v31, v14, 3, v31
    v_mov_b32 v28, 1073741824
    v_lshlrev_b32 v30, 3, v0
    v_cndmask_b32 v31, v28, v31, s[72:73]
    v_cndmask_b32 v11, v31, v30, s[74:75]
    s_mul_i32 s70, s62, 320
    s_add_u32 s70, s70, 2560
    s_andn2_b32 s70, s70, s74
    s_mul_i32 s71, s62, 1280
    s_and_b32 s71, s71, s74
    s_add_u32 s70, s70, s71
    s_and_b32 s52, s74, 384
    s_add_u32 s52, s52, 128
    s_lshl_b32 s62, s6, 4
    s_add_u32 s62, s62, s5
    s_mul_i32 s62, s62, 3200
    s_add_u32 s62, s62, 11296768
    s_add_u32 s51, s70, s62
    s_waitcnt vmcnt(10) lgkmcnt(0)
    s_barrier
    ds_read_b128 v[240:243], v68 offset:25728
    ds_read_b128 v[248:251], v69 offset:25728
    ds_read_b128 v[244:247], v70 offset:25728
    ds_read_b128 v[252:255], v71 offset:25728
    buffer_load_dwordx4 v1, s[40:43], s55 offen offset:2048 sc1 lds
    buffer_load_dwordx4 v1, s[40:43], s55 offen offset:3072 sc1 lds
    s_add_u32 s55, s55, 16384
    s_add_u32 m0, s56, 49152
    s_nop 0
    buffer_load_dwordx4 v1, s[40:43], s55 offen offset:0 sc1 lds
    buffer_load_dwordx4 v1, s[40:43], s55 offen offset:1024 sc1 lds
    buffer_load_dwordx4 v1, s[40:43], s55 offen offset:2048 sc1 lds
    buffer_load_dwordx4 v1, s[40:43], s55 offen offset:3072 sc1 lds
    s_add_u32 s55, s55, 16384
    s_waitcnt lgkmcnt(0)
    s_barrier
    s_branch L_A2
L_S2:
    s_setprio 0
    s_barrier
    ds_read_b128 v[144:147], v136 offset:25728
    ds_read_b128 v[148:151], v138 offset:25728
    ds_read_b128 v[152:155], v140 offset:25728
    ds_read_b128 v[156:159], v142 offset:27776
    ds_read_b128 v[160:163], v140 offset:29824
    ds_read_b128 v[164:167], v142 offset:31872
    ds_read_b128 v[168:171], v140 offset:33920
    ds_read_b128 v[172:175], v137 offset:25728
    ds_read_b128 v[176:179], v139 offset:25728
    ds_read_b128 v[180:183], v141 offset:25728
    ds_read_b128 v[184:187], v143 offset:27776
    ds_read_b128 v[188:191], v141 offset:29824
    ds_read_b128 v[192:195], v143 offset:31872
    ds_read_b128 v[196:199], v141 offset:33920
    v_subrev_u32 v136, 51456, v136
    v_subrev_u32 v137, 51456, v137
    v_subrev_u32 v138, 51456, v138
    v_subrev_u32 v139, 51456, v139
    v_subrev_u32 v140, 51456, v140
    v_subrev_u32 v141, 51456, v141
    v_subrev_u32 v142, 51456, v142
    v_subrev_u32 v143, 51456, v143
    s_lshr_b32 s61, s47, 2
    s_mul_i32 s62, s46, 27
    s_add_u32 s62, s62, s61
    s_cmp_lt_u32 s61, 27
    s_cselect_b32 s52, s62, s2
    s_lshl_b32 s52, s52, 7
    s_add_u32 s52, s52, 12124160
    s_mul_i32 s62, s6, 36
    s_lshr_b32 s62, s62, 6
    s_min_u32 s62, s62, 7
    s_mul_i32 s62, s62, 27
    v_mov_b32 v6, 0
    v_mov_b32 v7, 0
    v_min_u32 v121, 17, v0
    v_lshlrev_b32 v121, 7, v121
    s_lshl_b32 s74, s4, 2
    v_add_u32 v64, s74, v5
    v_mul_u32_u24 v64, 320, v64
    v_lshlrev_b32 v111, 2, v4
    v_add_u32 v111, 129024, v111
    v_add_u32 v108, v64, v111
    s_cmp_lg_u32 s4, 0
    s_cbranch_scc1 L_nogo0
    s_setprio 3
    global_load_dwordx2 v[60:61], v6, s[38:39] sc1
    s_setprio 0
L_nogo0:
    s_waitcnt lgkmcnt(0)
    s_barrier
    v_mfma_f32_16x16x32_bf16 v[8:11], v[144:147], v[152:155], 0
    ds_read_b128 v[200:203], v136 offset:0
    s_mul_i32 s74, s4, 5760
    s_mul_i32 s63, s4, 18
    v_mfma_f32_16x16x32_bf16 v[12:15], v[148:151], v[152:155], 0
    ds_read_b128 v[204:207], v138 offset:0
    s_add_u32 s74, s74, 134464
    s_add_u32 s62, s62, s63
    v_mfma_f32_16x16x32_bf16 v[16:19], v[144:147], v[156:159], 0
    ds_read_b128 v[208:211], v140 offset:0
    v_mul_u32_u24 v64, 80, v4
    s_lshl_b32 s62, s62, 7
    v_mfma_f32_16x16x32_bf16 v[20:23], v[148:151], v[156:159], 0
    ds_read_b128 v[212:215], v142 offset:2048
    v_lshl_add_u32 v64, v5, 4, v64
    s_add_u32 s56, s62, 12124160
    v_mfma_f32_16x16x32_bf16 v[24:27], v[144:147], v[160:163], 0
    ds_read_b128 v[216:219], v140 offset:4096
    v_add_u32 v109, s74, v64
    s_and_b32 s60, s2, 7
    v_mfma_f32_16x16x32_bf16 v[28:31], v[148:151], v[160:163], 0
    ds_read_b128 v[220:223], v142 offset:6144
    v_lshl_add_u32 v73, v4, 2, s74
    s_lshr_b32 s61, s2, 3
    v_mfma_f32_16x16x32_bf16 v[32:35], v[144:147], v[164:167], 0
    ds_read_b128 v[224:227], v140 offset:8192
    v_bfrev_b32 v64, v5
    s_lshr_b32 s63, s61, 3
    v_mfma_f32_16x16x32_bf16 v[36:39], v[148:151], v[164:167], 0
    ds_read_b128 v[228:231], v137 offset:0
    v_lshrrev_b32 v64, 24, v64
    s_lshl_b32 s62, s60, 2
    v_mfma_f32_16x16x32_bf16 v[40:43], v[144:147], v[168:171], 0
    ds_read_b128 v[232:235], v139 offset:0
    v_add_u32 v72, v73, v64
    s_add_u32 s44, s62, s63
    v_mfma_f32_16x16x32_bf16 v[44:47], v[148:151], v[168:171], 0
    ds_read_b128 v[236:239], v141 offset:0
    v_lshlrev_b32 v64, 7, v5
    s_and_b32 s45, s61, 7
    v_mfma_f32_16x16x32_bf16 v[8:11], v[172:175], v[180:183], v[8:11]
    ds_read_b128 v[240:243], v143 offset:2048
    v_and_b32 v65, 7, v0
    s_lshl_b32 s73, s6, 4
    v_mfma_f32_16x16x32_bf16 v[12:15], v[176:179], v[180:183], v[12:15]
    ds_read_b128 v[244:247], v141 offset:4096
    v_lshl_add_u32 v64, v65, 4, v64
    s_add_u32 s73, s73, s5
    v_mfma_f32_16x16x32_bf16 v[16:19], v[172:175], v[184:187], v[16:19]
    ds_read_b128 v[248:251], v143 offset:6144
    v_add_u32 v110, 4096, v64
    s_mul_i32 s72, s73, 640
    v_mfma_f32_16x16x32_bf16 v[20:23], v[176:179], v[184:187], v[20:23]
    ds_read_b128 v[252:255], v141 offset:8192
    v_bfe_u32 v64, v0, 2, 2
    s_add_u32 s72, s72, 11132928
    v_mfma_f32_16x16x32_bf16 v[24:27], v[172:175], v[188:191], v[24:27]
    v_mul_u32_u24 v64, 160, v64
    v_and_b32 v65, 3, v0
    s_lshl_b32 s73, s73, 7
    v_mfma_f32_16x16x32_bf16 v[28:31], v[176:179], v[188:191], v[28:31]
    v_lshl_add_u32 v64, v65, 3, v64
    v_add_u32 v64, s74, v64
    s_add_u32 s73, s73, 12189696
    v_mfma_f32_16x16x32_bf16 v[32:35], v[172:175], v[192:195], v[32:35]
    v_mul_u32_u24 v65, 640, v5
    v_add_u32 v128, v64, v65
    s_lshl_b32 s58, s44, 3
    v_mfma_f32_16x16x32_bf16 v[36:39], v[176:179], v[192:195], v[36:39]
    v_add_u32 v129, 2560, v128
    v_add_u32 v131, 1952, v128
    s_add_u32 s58, s58, s45
    v_mfma_f32_16x16x32_bf16 v[40:43], v[172:175], v[196:199], v[40:43]
    v_cmp_eq_u32 s[68:69], 0, v5
    v_add_u32 v66, 5120, v128
    s_lshl_b32 s58, s58, 9
    v_mfma_f32_16x16x32_bf16 v[44:47], v[176:179], v[196:199], v[44:47]
    v_subrev_u32 v130, 608, v128
    v_cndmask_b32 v130, v130, v66, s[68:69]
    s_add_u32 s58, s58, 12222464
    s_cmp_lg_u32 s4, 0
    s_cbranch_scc1 L_nogo
    s_mov_b32 s59, 0
    s_waitcnt vmcnt(0)
    s_branch Lr_40
Lp_38:
    s_sleep 4
    global_load_dwordx2 v[60:61], v6, s[38:39] sc1
    s_waitcnt vmcnt(0)
Lr_40:
    s_add_u32 s59, s59, 1
    v_cmp_eq_u32 vcc, 0, v61
    s_cmp_gt_u32 s59, 100000
    s_cbranch_scc1 Lq_39
    s_cbranch_vccnz Lp_38
Lq_39:
    ds_write_b64 v3, v[60:61] offset:16
    v_mov_b32 v62, v60
    v_mov_b32 v63, v61
L_nogo:
    s_waitcnt vmcnt(0)
    s_waitcnt lgkmcnt(0)
    s_barrier
    s_cmp_lg_u32 s4, 0
    s_cbranch_scc1 L_nod0
    s_setprio 3
    s_mov_b64 exec, 0xf
    buffer_store_dwordx4 v[60:63], v1, s[40:43], s52 offen sc1
    s_mov_b64 exec, -1
    s_setprio 0
L_nod0:
    ds_read_b64 v[104:105], v2 offset:32
    v_mfma_f32_16x16x32_bf16 v[8:11], v[200:203], v[208:211], v[8:11]
    ds_read_b128 v[144:147], v136 offset:25728
    v_lshlrev_b32 v98, 16, v98
    s_lshl_b32 s61, s5, 1
    v_mfma_f32_16x16x32_bf16 v[12:15], v[204:207], v[208:211], v[12:15]
    ds_read_b128 v[148:151], v138 offset:25728
    v_lshlrev_b32 v99, 16, v99
    s_lshr_b32 s62, s4, 1
    v_mfma_f32_16x16x32_bf16 v[16:19], v[200:203], v[212:215], v[16:19]
    ds_read_b128 v[152:155], v140 offset:25728
    v_lshlrev_b32 v100, 16, v100
    s_add_u32 s75, s61, s62
    v_mfma_f32_16x16x32_bf16 v[20:23], v[204:207], v[212:215], v[20:23]
    ds_read_b128 v[156:159], v142 offset:27776
    v_mul_f32 v100, 1069066811, v100
    s_lshl_b32 s75, s75, 12
    v_mfma_f32_16x16x32_bf16 v[24:27], v[200:203], v[216:219], v[24:27]
    ds_read_b128 v[160:163], v140 offset:29824
    v_exp_f32 v100, v100
    s_and_b32 s62, s4, 1
    v_mfma_f32_16x16x32_bf16 v[28:31], v[204:207], v[216:219], v[28:31]
    ds_read_b128 v[164:167], v142 offset:31872
    v_cvt_pk_bf16_f32 v100, v100, v100
    s_lshl_b32 s62, s62, 7
    v_mfma_f32_16x16x32_bf16 v[32:35], v[200:203], v[220:223], v[32:35]
    ds_read_b128 v[168:171], v140 offset:33920
    v_lshlrev_b32 v100, 16, v100
    s_add_u32 s75, s75, s62
    v_mfma_f32_16x16x32_bf16 v[36:39], v[204:207], v[220:223], v[36:39]
    ds_read_b128 v[172:175], v137 offset:25728
    v_mul_f32 v88, v100, v98
    s_lshl_b32 s62, s6, 3
    v_mfma_f32_16x16x32_bf16 v[40:43], v[200:203], v[224:227], v[40:43]
    ds_read_b128 v[176:179], v139 offset:25728
    v_mul_f32 v89, v100, v99
    s_add_u32 s75, s75, s62
    v_mfma_f32_16x16x32_bf16 v[44:47], v[204:207], v[224:227], v[44:47]
    ds_read_b128 v[180:183], v141 offset:25728
    v_mul_f32 v48, 1069066811, v88
    s_add_u32 s75, s75, 12222464
    v_mfma_f32_16x16x32_bf16 v[8:11], v[228:231], v[236:239], v[8:11]
    ds_read_b128 v[184:187], v143 offset:27776
    v_exp_f32 v88, v48
    s_mul_i32 s61, s45, 72
    v_mfma_f32_16x16x32_bf16 v[12:15], v[232:235], v[236:239], v[12:15]
    ds_read_b128 v[188:191], v141 offset:29824
    v_mul_f32 v49, 0.15915494, v89
    s_lshr_b32 s61, s61, 6
    v_mfma_f32_16x16x32_bf16 v[16:19], v[228:231], v[240:243], v[16:19]
    ds_read_b128 v[192:195], v143 offset:31872
    v_fract_f32 v89, v49
    s_mul_i32 s61, s61, 27
    v_mfma_f32_16x16x32_bf16 v[20:23], v[232:235], v[240:243], v[20:23]
    ds_read_b128 v[196:199], v141 offset:33920
    v_cos_f32 v90, v89
    s_mul_i32 s62, s4, 18
    v_mfma_f32_16x16x32_bf16 v[24:27], v[228:231], v[244:247], v[24:27]
    v_add_u32 v136, 51456, v136
    v_add_u32 v137, 51456, v137
    v_sin_f32 v91, v89
    s_add_u32 s61, s61, s62
    v_mfma_f32_16x16x32_bf16 v[28:31], v[232:235], v[244:247], v[28:31]
    v_add_u32 v138, 51456, v138
    v_add_u32 v139, 51456, v139
    v_mul_f32 v90, v88, v90
    s_lshl_b32 s61, s61, 7
    v_mfma_f32_16x16x32_bf16 v[32:35], v[228:231], v[248:251], v[32:35]
    v_add_u32 v140, 51456, v140
    v_add_u32 v141, 51456, v141
    v_mul_f32 v91, v88, v91
    s_add_u32 s51, s61, 12156928
    v_mfma_f32_16x16x32_bf16 v[36:39], v[232:235], v[248:251], v[36:39]
    v_add_u32 v142, 51456, v142
    v_add_u32 v143, 51456, v143
    v_mul_f32 v88, v98, v98
    s_lshl_b32 s61, s6, 11
    v_mfma_f32_16x16x32_bf16 v[40:43], v[228:231], v[252:255], v[40:43]
    v_fmac_f32 v88, v99, v99
    v_and_b32 v66, 1, v5
    s_add_u32 s61, s61, 12189696
    v_mfma_f32_16x16x32_bf16 v[44:47], v[232:235], v[252:255], v[44:47]
    v_rcp_f32 v88, v88
    v_mul_u32_u24 v66, 640, v66
    s_cmp_eq_u32 s4, 3
    s_cselect_b32 s51, s61, s51
    s_cselect_b32 s49, 15, 17
    s_cmp_lg_u32 s4, 3
    s_cbranch_scc1 L_nowarm
    s_setprio 3
    s_mov_b32 exec_hi, 0xf
    buffer_store_dwordx4 v[4:7], v1, s[40:43], s72 offen sc1
    s_lshl_b32 s20, s5, 9
    s_add_u32 s20, s20, 12115968
    s_cmp_eq_u32 s6, 0
    s_cselect_b32 s20, s20, 1073741824
    s_mov_b32 exec_hi, 0
    buffer_store_dwordx4 v[4:7], v1, s[40:43], s20 offen sc1
    s_add_u32 s20, s52, 32768
    s_mov_b64 exec, 0xf
    buffer_store_dwordx4 v[4:7], v1, s[40:43], s20 offen sc1
    buffer_store_dwordx4 v[4:7], v1, s[40:43], s73 offen sc1
    s_mov_b64 exec, 0xff
    v_lshlrev_b32 v103, 6, v0
    buffer_atomic_or v6, v103, s[40:43], s58 offen sc1
    s_mov_b64 exec, -1
    s_setprio 0
L_nowarm:
    s_waitcnt lgkmcnt(0)
    s_barrier
    v_readfirstlane_b32 s100, v104
    v_readfirstlane_b32 s101, v105
    v_mfma_f32_16x16x32_bf16 v[8:11], v[144:147], v[152:155], v[8:11]
    ds_read_b128 v[200:203], v136 offset:0
    v_add_f32 v89, -1.0, v90
    s_mul_i32 s64, s45, 248832
    v_mfma_f32_16x16x32_bf16 v[12:15], v[148:151], v[152:155], v[12:15]
    ds_read_b128 v[204:207], v138 offset:0
    v_add_f32 v88, v88, v88
    s_add_u32 s64, s64, 2064384
    v_mfma_f32_16x16x32_bf16 v[16:19], v[144:147], v[156:159], v[16:19]
    ds_read_b128 v[208:211], v140 offset:0
    v_mul_f32 v92, v89, v98
    s_mul_i32 s66, s4, 41472
    v_mfma_f32_16x16x32_bf16 v[20:23], v[148:151], v[156:159], v[20:23]
    ds_read_b128 v[212:215], v142 offset:2048
    v_fmac_f32 v92, v91, v99
    s_add_u32 s66, s66, s64
    v_mfma_f32_16x16x32_bf16 v[24:27], v[144:147], v[160:163], v[24:27]
    ds_read_b128 v[216:219], v140 offset:4096
    v_mul_f32 v92, v92, v88
    s_lshl_b32 s61, s5, 9
    v_mfma_f32_16x16x32_bf16 v[28:31], v[148:151], v[160:163], v[28:31]
    ds_read_b128 v[220:223], v142 offset:6144
    v_mul_f32 v93, v89, v99
    s_lshl_b32 s62, s4, 7
    v_mfma_f32_16x16x32_bf16 v[32:35], v[144:147], v[164:167], v[32:35]
    ds_read_b128 v[224:227], v140 offset:8192
    v_fma_f32 v93, -v91, v98, v93
    s_add_u32 s61, s61, s62
    v_mfma_f32_16x16x32_bf16 v[36:39], v[148:151], v[164:167], v[36:39]
    ds_read_b128 v[228:231], v137 offset:0
    v_mul_f32 v93, v93, v88
    s_add_u32 s61, s61, 12115968
    v_mfma_f32_16x16x32_bf16 v[40:43], v[144:147], v[168:171], v[40:43]
    ds_read_b128 v[232:235], v139 offset:0
    v_mov_b32 v94, v90
    s_cmp_eq_u32 s6, 0
    s_cselect_b32 s54, s61, 1073741824
    v_mfma_f32_16x16x32_bf16 v[44:47], v[148:151], v[168:171], v[44:47]
    ds_read_b128 v[236:239], v141 offset:0
    v_xor_b32 v95, 0x80000000, v91
    s_lshl_b32 s61, s5, 3
    v_mfma_f32_16x16x32_bf16 v[8:11], v[172:175], v[180:183], v[8:11]
    ds_read_b128 v[240:243], v143 offset:2048
    v_xor_b32 v96, 0x80000000, v92
    s_lshl_b32 s62, s4, 1
    v_mfma_f32_16x16x32_bf16 v[12:15], v[176:179], v[180:183], v[12:15]
    ds_read_b128 v[244:247], v141 offset:4096
    v_mov_b32 v97, v93
    s_add_u32 s61, s61, s62
    v_mfma_f32_16x16x32_bf16 v[16:19], v[172:175], v[184:187], v[16:19]
    ds_read_b128 v[248:251], v143 offset:6144
    v_lshlrev_b32 v88, 5, v0
    s_mul_i32 s61, s61, 36864
    v_mfma_f32_16x16x32_bf16 v[20:23], v[176:179], v[184:187], v[20:23]
    ds_read_b128 v[252:255], v141 offset:8192
    v_add_u32 v88, 162304, v88
    s_mul_i32 s62, s6, 2304
    v_mfma_f32_16x16x32_bf16 v[24:27], v[172:175], v[188:191], v[24:27]
    v_lshlrev_b32 v135, 3, v0
    v_add_u32 v66, 4512, v66
    s_add_u32 s61, s61, s62
    v_mfma_f32_16x16x32_bf16 v[28:31], v[176:179], v[188:191], v[28:31]
    v_add_u32 v135, 129344, v135
    v_add_u32 v132, v64, v66
    s_add_u32 s55, s61, 4055040
    v_mfma_f32_16x16x32_bf16 v[32:35], v[172:175], v[192:195], v[32:35]
    v_add_u32 v134, 34560, v1
    v_cndmask_b32 v133, v134, v1, s[68:69]
    s_lshl_b32 s48, s4, 12
    v_mfma_f32_16x16x32_bf16 v[36:39], v[176:179], v[192:195], v[36:39]
    v_lshlrev_b32 v68, 4, v4
    v_add_u32 v68, 162304, v68
    s_mul_i32 s50, s6, 129024
    v_mfma_f32_16x16x32_bf16 v[40:43], v[172:175], v[196:199], v[40:43]
    v_lshrrev_b32 v69, 1, v4
    v_lshlrev_b32 v69, 3, v69
    s_add_u32 s50, s50, 98304
    v_mfma_f32_16x16x32_bf16 v[44:47], v[176:179], v[196:199], v[44:47]
    v_add_u32 v69, 163456, v69
    s_add_u32 s50, s50, s48
    s_waitcnt lgkmcnt(0)
    s_barrier
    v_mfma_f32_16x16x32_bf16 v[8:11], v[200:203], v[208:211], v[8:11]
    ds_read_b128 v[144:147], v136 offset:25728
    s_lshl_b32 s74, s4, 5
    s_mul_i32 s61, s6, 10240
    v_mfma_f32_16x16x32_bf16 v[12:15], v[204:207], v[208:211], v[12:15]
    ds_read_b128 v[148:151], v138 offset:25728
    v_cvt_f32_u32 v74, s74
    s_add_u32 s61, s61, 11132928
    v_mfma_f32_16x16x32_bf16 v[16:19], v[200:203], v[212:215], v[16:19]
    ds_read_b128 v[152:155], v140 offset:25728
    v_mul_f32 v75, 0x41800000, v74
    s_add_u32 s28, s40, s61
    s_addc_u32 s29, s41, 0
    v_mfma_f32_16x16x32_bf16 v[20:23], v[204:207], v[212:215], v[20:23]
    ds_read_b128 v[156:159], v142 offset:27776
    v_mul_f32 v114, 0x41000000, v48
    s_mov_b32 s30, 10240
    v_mfma_f32_16x16x32_bf16 v[24:27], v[200:203], v[216:219], v[24:27]
    ds_read_b128 v[160:163], v140 offset:29824
    v_mul_f32 v113, 0x41000000, v49
    s_mov_b32 s31, 0x20000
    v_mfma_f32_16x16x32_bf16 v[28:31], v[204:207], v[216:219], v[28:31]
    ds_read_b128 v[164:167], v142 offset:31872
    v_mul_f32 v124, 0x43000000, v48
    s_lshl_b32 s61, s4, 2
    v_mfma_f32_16x16x32_bf16 v[32:35], v[200:203], v[220:223], v[32:35]
    ds_read_b128 v[168:171], v140 offset:33920
    v_mul_f32 v123, 0x43000000, v49
    s_sub_i32 s61, s5, s61
    v_mfma_f32_16x16x32_bf16 v[36:39], v[204:207], v[220:223], v[36:39]
    ds_read_b128 v[172:175], v137 offset:25728
    v_mul_f32 v117, 0x42000000, v48
    s_max_i32 s65, s61, 0
    v_mfma_f32_16x16x32_bf16 v[40:43], v[200:203], v[224:227], v[40:43]
    ds_read_b128 v[176:179], v139 offset:25728
    v_mul_f32 v116, 0x42000000, v49
    s_min_i32 s65, s65, 4
    v_mfma_f32_16x16x32_bf16 v[44:47], v[204:207], v[224:227], v[44:47]
    ds_read_b128 v[180:183], v141 offset:25728
    v_mul_f32 v120, v74, v48
    s_sub_i32 s61, s61, 4
    v_mfma_f32_16x16x32_bf16 v[8:11], v[228:231], v[236:239], v[8:11]
    ds_read_b128 v[184:187], v143 offset:27776
    v_mul_f32 v119, v74, v49
    s_mul_i32 s57, s61, 640
    v_mfma_f32_16x16x32_bf16 v[12:15], v[232:235], v[236:239], v[12:15]
    ds_read_b128 v[188:191], v141 offset:29824
    v_mul_f32 v127, v75, v48
    s_lshl_b32 s63, s4, 5
    v_mfma_f32_16x16x32_bf16 v[16:19], v[228:231], v[240:243], v[16:19]
    ds_read_b128 v[192:195], v143 offset:31872
    v_mul_f32 v126, v75, v49
    s_add_u32 s63, s63, s58
    v_mfma_f32_16x16x32_bf16 v[20:23], v[232:235], v[240:243], v[20:23]
    ds_read_b128 v[196:199], v141 offset:33920
    v_exp_f32 v114, v114
    s_add_u32 s18, s40, s63
    s_addc_u32 s19, s41, 0
    v_mfma_f32_16x16x32_bf16 v[24:27], v[228:231], v[244:247], v[24:27]
    v_subrev_u32 v136, 51456, v136
    v_subrev_u32 v137, 51456, v137
    v_fract_f32 v113, v113
    s_lshr_b32 s63, s4, 1
    v_mfma_f32_16x16x32_bf16 v[28:31], v[232:235], v[244:247], v[28:31]
    v_subrev_u32 v138, 51456, v138
    v_subrev_u32 v139, 51456, v139
    v_exp_f32 v124, v124
    s_lshl_b32 s63, s63, 7
    v_mfma_f32_16x16x32_bf16 v[32:35], v[228:231], v[248:251], v[32:35]
    v_subrev_u32 v140, 51456, v140
    v_subrev_u32 v141, 51456, v141
    v_fract_f32 v123, v123
    s_add_u32 s63, s63, s58
    v_mfma_f32_16x16x32_bf16 v[36:39], v[232:235], v[248:251], v[36:39]
    v_subrev_u32 v142, 51456, v142
    v_subrev_u32 v143, 51456, v143
    v_exp_f32 v117, v117
    s_add_u32 s14, s40, s63
    s_addc_u32 s15, s41, 0
    v_mfma_f32_16x16x32_bf16 v[40:43], v[228:231], v[252:255], v[40:43]
    v_fract_f32 v116, v116
    v_exp_f32 v120, v120
    s_mul_i32 s67, s4, 18688
    v_mfma_f32_16x16x32_bf16 v[44:47], v[232:235], v[252:255], v[44:47]
    v_fract_f32 v119, v119
    v_exp_f32 v127, v127
    s_add_u32 s67, s67, 82944
    s_cmp_lg_u32 s4, 0
    s_cbranch_scc1 L_nodb
    s_mov_b32 exec_hi, 0xf
    ds_write_b128 v88, v[90:93]
    ds_write_b128 v88, v[94:97] offset:16
    ds_write_b64 v135, v[48:49] offset:34112
    s_mov_b64 exec, -1
L_nodb:
    s_cmp_eq_u32 s4, 3
    s_cbranch_scc1 L_np0
    s_setprio 3
    buffer_load_dwordx2 v[106:107], v121, s[40:43], s56 offen sc1
    s_setprio 0
L_np0:
    s_waitcnt lgkmcnt(0)
    s_barrier
    v_mfma_f32_16x16x32_bf16 v[8:11], v[144:147], v[152:155], v[8:11]
    ds_read_b128 v[200:203], v136 offset:0
    v_fract_f32 v126, v126
    v_mfma_f32_16x16x32_bf16 v[12:15], v[148:151], v[152:155], v[12:15]
    ds_read_b128 v[204:207], v138 offset:0
    v_cos_f32 v112, v113
    v_mfma_f32_16x16x32_bf16 v[16:19], v[144:147], v[156:159], v[16:19]
    ds_read_b128 v[208:211], v140 offset:0
    v_cos_f32 v122, v123
    v_mfma_f32_16x16x32_bf16 v[20:23], v[148:151], v[156:159], v[20:23]
    ds_read_b128 v[212:215], v142 offset:2048
    v_cos_f32 v115, v116
    v_mfma_f32_16x16x32_bf16 v[24:27], v[144:147], v[160:163], v[24:27]
    ds_read_b128 v[216:219], v140 offset:4096
    v_cos_f32 v118, v119
    v_mfma_f32_16x16x32_bf16 v[28:31], v[148:151], v[160:163], v[28:31]
    ds_read_b128 v[220:223], v142 offset:6144
    v_cos_f32 v125, v126
    v_mfma_f32_16x16x32_bf16 v[32:35], v[144:147], v[164:167], v[32:35]
    ds_read_b128 v[224:227], v140 offset:8192
    v_sin_f32 v113, v113
    v_mfma_f32_16x16x32_bf16 v[36:39], v[148:151], v[164:167], v[36:39]
    ds_read_b128 v[228:231], v137 offset:0
    v_sin_f32 v123, v123
    v_mfma_f32_16x16x32_bf16 v[40:43], v[144:147], v[168:171], v[40:43]
    ds_read_b128 v[232:235], v139 offset:0
    v_sin_f32 v116, v116
    v_mfma_f32_16x16x32_bf16 v[44:47], v[148:151], v[168:171], v[44:47]
    ds_read_b128 v[236:239], v141 offset:0
    v_sin_f32 v119, v119
    v_mfma_f32_16x16x32_bf16 v[8:11], v[172:175], v[180:183], v[8:11]
    ds_read_b128 v[240:243], v143 offset:2048
    v_sin_f32 v126, v126
    v_mfma_f32_16x16x32_bf16 v[12:15], v[176:179], v[180:183], v[12:15]
    ds_read_b128 v[244:247], v141 offset:4096
    v_mul_f32 v112, v114, v112
    v_mfma_f32_16x16x32_bf16 v[16:19], v[172:175], v[184:187], v[16:19]
    ds_read_b128 v[248:251], v143 offset:6144
    v_mul_f32 v113, v114, v113
    v_mfma_f32_16x16x32_bf16 v[20:23], v[176:179], v[184:187], v[20:23]
    ds_read_b128 v[252:255], v141 offset:8192
    v_mul_f32 v122, v124, v122
    v_mfma_f32_16x16x32_bf16 v[24:27], v[172:175], v[188:191], v[24:27]
    v_mul_f32 v123, v124, v123
    v_mul_f32 v115, v117, v115
    v_mfma_f32_16x16x32_bf16 v[28:31], v[176:179], v[188:191], v[28:31]
    v_mul_f32 v116, v117, v116
    v_mul_f32 v118, v120, v118
    v_mfma_f32_16x16x32_bf16 v[32:35], v[172:175], v[192:195], v[32:35]
    v_mul_f32 v119, v120, v119
    v_mul_f32 v125, v127, v125
    v_mfma_f32_16x16x32_bf16 v[36:39], v[176:179], v[192:195], v[36:39]
    v_mul_f32 v126, v127, v126
    v_xor_b32 v114, 0x80000000, v113
    v_mfma_f32_16x16x32_bf16 v[40:43], v[172:175], v[196:199], v[40:43]
    v_xor_b32 v124, 0x80000000, v123
    v_xor_b32 v117, 0x80000000, v116
    v_mfma_f32_16x16x32_bf16 v[44:47], v[176:179], v[196:199], v[44:47]
    v_xor_b32 v120, 0x80000000, v119
    v_xor_b32 v127, 0x80000000, v126
    s_cmp_eq_u32 s4, 3
    s_cbranch_scc1 L_np1
    s_mov_b32 s59, 0
    s_waitcnt vmcnt(0)
    s_branch Lr_43
Lp_41:
    s_sleep 1
    buffer_load_dwordx2 v[106:107], v121, s[40:43], s56 offen sc1
    s_waitcnt vmcnt(0)
Lr_43:
    s_add_u32 s59, s59, 1
    v_cmp_ne_u64 vcc, s[100:101], v[106:107]
    s_cmp_gt_u32 s59, 100000
    s_cbranch_scc1 Lq_42
    s_cbranch_vccnz Lp_41
Lq_42:
L_np1:
    s_waitcnt vmcnt(1)
    s_waitcnt lgkmcnt(0)
    s_barrier
    v_mfma_f32_16x16x32_bf16 v[8:11], v[200:203], v[208:211], v[8:11]
    ds_read_b128 v[88:91], v68 offset:0
    ds_read_b64 v[78:79], v69 offset:0
    ds_read_b128 v[144:147], v136 offset:25728
    v_mfma_f32_16x16x32_bf16 v[12:15], v[204:207], v[208:211], v[12:15]
    ds_read_b128 v[92:95], v68 offset:256
    ds_read_b64 v[80:81], v69 offset:64
    ds_read_b128 v[148:151], v138 offset:25728
    v_mfma_f32_16x16x32_bf16 v[16:19], v[200:203], v[212:215], v[16:19]
    ds_read_b128 v[96:99], v68 offset:512
    ds_read_b64 v[82:83], v69 offset:128
    ds_read_b128 v[152:155], v140 offset:25728
    v_mfma_f32_16x16x32_bf16 v[20:23], v[204:207], v[212:215], v[20:23]
    ds_read_b128 v[100:103], v68 offset:768
    ds_read_b64 v[84:85], v69 offset:192
    ds_read_b128 v[156:159], v142 offset:27776
    v_mfma_f32_16x16x32_bf16 v[24:27], v[200:203], v[216:219], v[24:27]
    ds_read_b128 v[104:107], v68 offset:1024
    ds_read_b64 v[86:87], v69 offset:256
    ds_read_b128 v[160:163], v140 offset:29824
    v_mfma_f32_16x16x32_bf16 v[28:31], v[204:207], v[216:219], v[28:31]
    ds_read_b128 v[164:167], v142 offset:31872
    v_mfma_f32_16x16x32_bf16 v[32:35], v[200:203], v[220:223], v[32:35]
    ds_read_b128 v[168:171], v140 offset:33920
    v_mfma_f32_16x16x32_bf16 v[36:39], v[204:207], v[220:223], v[36:39]
    ds_read_b128 v[172:175], v137 offset:25728
    v_mfma_f32_16x16x32_bf16 v[40:43], v[200:203], v[224:227], v[40:43]
    ds_read_b128 v[176:179], v139 offset:25728
    v_mfma_f32_16x16x32_bf16 v[44:47], v[204:207], v[224:227], v[44:47]
    ds_read_b128 v[180:183], v141 offset:25728
    v_mfma_f32_16x16x32_bf16 v[8:11], v[228:231], v[236:239], v[8:11]
    ds_read_b128 v[184:187], v143 offset:27776
    v_mfma_f32_16x16x32_bf16 v[12:15], v[232:235], v[236:239], v[12:15]
    ds_read_b128 v[188:191], v141 offset:29824
    v_mfma_f32_16x16x32_bf16 v[16:19], v[228:231], v[240:243], v[16:19]
    ds_read_b128 v[192:195], v143 offset:31872
    v_mfma_f32_16x16x32_bf16 v[20:23], v[232:235], v[240:243], v[20:23]
    ds_read_b128 v[196:199], v141 offset:33920
    v_mfma_f32_16x16x32_bf16 v[24:27], v[228:231], v[244:247], v[24:27]
    v_add_u32 v136, 51456, v136
    v_add_u32 v137, 51456, v137
    v_mfma_f32_16x16x32_bf16 v[28:31], v[232:235], v[244:247], v[28:31]
    v_add_u32 v138, 51456, v138
    v_add_u32 v139, 51456, v139
    v_mfma_f32_16x16x32_bf16 v[32:35], v[228:231], v[248:251], v[32:35]
    v_add_u32 v140, 51456, v140
    v_add_u32 v141, 51456, v141
    v_mfma_f32_16x16x32_bf16 v[36:39], v[232:235], v[248:251], v[36:39]
    v_add_u32 v142, 51456, v142
    v_add_u32 v143, 51456, v143
    v_mfma_f32_16x16x32_bf16 v[40:43], v[228:231], v[252:255], v[40:43]
    v_mfma_f32_16x16x32_bf16 v[44:47], v[232:235], v[252:255], v[44:47]
    s_waitcnt lgkmcnt(0)
    s_barrier
    v_mfma_f32_16x16x32_bf16 v[8:11], v[144:147], v[152:155], v[8:11]
    ds_read_b128 v[200:203], v136 offset:0
    v_lshlrev_b32 v77, 3, v5
    v_mfma_f32_16x16x32_bf16 v[12:15], v[148:151], v[152:155], v[12:15]
    ds_read_b128 v[204:207], v138 offset:0
    v_lshlrev_b32 v51, 31, v0
    v_mfma_f32_16x16x32_bf16 v[16:19], v[144:147], v[156:159], v[16:19]
    ds_read_b128 v[208:211], v140 offset:0
    v_sub_u32 v77, 24, v77
    v_mfma_f32_16x16x32_bf16 v[20:23], v[148:151], v[156:159], v[20:23]
    ds_read_b128 v[212:215], v142 offset:2048
    v_cvt_f32_u32 v77, v77
    v_mfma_f32_16x16x32_bf16 v[24:27], v[144:147], v[160:163], v[24:27]
    ds_read_b128 v[216:219], v140 offset:4096
    v_xor_b32 v51, v77, v51
    v_mfma_f32_16x16x32_bf16 v[28:31], v[148:151], v[160:163], v[28:31]
    ds_read_b128 v[220:223], v142 offset:6144
    v_mul_f32 v52, v77, v78
    v_mfma_f32_16x16x32_bf16 v[32:35], v[144:147], v[164:167], v[32:35]
    ds_read_b128 v[224:227], v140 offset:8192
    v_mul_f32 v79, v51, v79
    v_mfma_f32_16x16x32_bf16 v[36:39], v[148:151], v[164:167], v[36:39]
    ds_read_b128 v[228:231], v137 offset:0
    v_mul_f32 v53, v77, v80
    v_mfma_f32_16x16x32_bf16 v[40:43], v[144:147], v[168:171], v[40:43]
    ds_read_b128 v[232:235], v139 offset:0
    v_mul_f32 v81, v51, v81
    v_mfma_f32_16x16x32_bf16 v[44:47], v[148:151], v[168:171], v[44:47]
    ds_read_b128 v[236:239], v141 offset:0
    v_mul_f32 v54, v77, v82
    v_mfma_f32_16x16x32_bf16 v[8:11], v[172:175], v[180:183], v[8:11]
    ds_read_b128 v[240:243], v143 offset:2048
    v_mul_f32 v83, v51, v83
    v_mfma_f32_16x16x32_bf16 v[12:15], v[176:179], v[180:183], v[12:15]
    ds_read_b128 v[244:247], v141 offset:4096
    v_mul_f32 v55, v77, v84
    v_mfma_f32_16x16x32_bf16 v[16:19], v[172:175], v[184:187], v[16:19]
    ds_read_b128 v[248:251], v143 offset:6144
    v_mul_f32 v85, v51, v85
    v_mfma_f32_16x16x32_bf16 v[20:23], v[176:179], v[184:187], v[20:23]
    ds_read_b128 v[252:255], v141 offset:8192
    v_mul_f32 v56, v77, v86
    v_mfma_f32_16x16x32_bf16 v[24:27], v[172:175], v[188:191], v[24:27]
    v_mul_f32 v87, v51, v87
    v_exp_f32 v52, v52
    v_mfma_f32_16x16x32_bf16 v[28:31], v[176:179], v[188:191], v[28:31]
    v_fract_f32 v79, v79
    v_exp_f32 v53, v53
    v_mfma_f32_16x16x32_bf16 v[32:35], v[172:175], v[192:195], v[32:35]
    v_fract_f32 v81, v81
    v_exp_f32 v54, v54
    v_mfma_f32_16x16x32_bf16 v[36:39], v[176:179], v[192:195], v[36:39]
    v_fract_f32 v83, v83
    v_exp_f32 v55, v55
    v_mfma_f32_16x16x32_bf16 v[40:43], v[172:175], v[196:199], v[40:43]
    v_fract_f32 v85, v85
    v_exp_f32 v56, v56
    v_mfma_f32_16x16x32_bf16 v[44:47], v[176:179], v[196:199], v[44:47]
    v_fract_f32 v87, v87
    v_cos_f32 v78, v79
    s_waitcnt lgkmcnt(0)
    s_barrier
    s_setprio 2
    s_cmp_lg_u32 s4, 0
    s_cbranch_scc1 L_nodb2
    s_add_u32 s52, s52, 32768
    s_mov_b64 exec, 0xf
    buffer_store_dwordx4 v[60:63], v1, s[40:43], s52 offen sc1
    buffer_store_dwordx4 v[60:63], v1, s[40:43], s73 offen sc1
    s_mov_b64 exec, -1
L_nodb2:
    v_mfma_f32_16x16x32_bf16 v[8:11], v[200:203], v[208:211], v[8:11]
    ds_read_b128 v[144:147], v136 offset:25728
    v_cos_f32 v80, v81
    v_mfma_f32_16x16x32_bf16 v[12:15], v[204:207], v[208:211], v[12:15]
    ds_read_b128 v[148:151], v138 offset:25728
    v_cos_f32 v82, v83
    v_mfma_f32_16x16x32_bf16 v[16:19], v[200:203], v[212:215], v[16:19]
    ds_read_b128 v[152:155], v140 offset:25728
    v_cos_f32 v84, v85
    v_mfma_f32_16x16x32_bf16 v[20:23], v[204:207], v[212:215], v[20:23]
    ds_read_b128 v[156:159], v142 offset:27776
    v_cos_f32 v86, v87
    v_mfma_f32_16x16x32_bf16 v[24:27], v[200:203], v[216:219], v[24:27]
    ds_read_b128 v[160:163], v140 offset:29824
    v_sin_f32 v79, v79
    v_mfma_f32_16x16x32_bf16 v[28:31], v[204:207], v[216:219], v[28:31]
    ds_read_b128 v[164:167], v142 offset:31872
    v_sin_f32 v81, v81
    v_mfma_f32_16x16x32_bf16 v[32:35], v[200:203], v[220:223], v[32:35]
    ds_read_b128 v[168:171], v140 offset:33920
    v_sin_f32 v83, v83
    v_mfma_f32_16x16x32_bf16 v[36:39], v[204:207], v[220:223], v[36:39]
    ds_read_b128 v[172:175], v137 offset:25728
    v_sin_f32 v85, v85
    v_mfma_f32_16x16x32_bf16 v[40:43], v[200:203], v[224:227], v[40:43]
    ds_read_b128 v[176:179], v139 offset:25728
    v_sin_f32 v87, v87
    v_mfma_f32_16x16x32_bf16 v[44:47], v[204:207], v[224:227], v[44:47]
    ds_read_b128 v[180:183], v141 offset:25728
    v_mul_f32 v78, v52, v78
    v_mfma_f32_16x16x32_bf16 v[8:11], v[228:231], v[236:239], v[8:11]
    ds_read_b128 v[184:187], v143 offset:27776
    v_mul_f32 v79, v52, v79
    v_mfma_f32_16x16x32_bf16 v[12:15], v[232:235], v[236:239], v[12:15]
    ds_read_b128 v[188:191], v141 offset:29824
    v_mul_f32 v80, v53, v80
    v_mfma_f32_16x16x32_bf16 v[16:19], v[228:231], v[240:243], v[16:19]
    ds_read_b128 v[192:195], v143 offset:31872
    v_mul_f32 v81, v53, v81
    v_mfma_f32_16x16x32_bf16 v[20:23], v[232:235], v[240:243], v[20:23]
    ds_read_b128 v[196:199], v141 offset:33920
    v_mul_f32 v82, v54, v82
    v_mfma_f32_16x16x32_bf16 v[24:27], v[228:231], v[244:247], v[24:27]
    v_mul_f32 v83, v54, v83
    v_mul_f32 v84, v55, v84
    v_mfma_f32_16x16x32_bf16 v[28:31], v[232:235], v[244:247], v[28:31]
    v_mul_f32 v85, v55, v85
    v_mul_f32 v86, v56, v86
    v_mfma_f32_16x16x32_bf16 v[32:35], v[228:231], v[248:251], v[32:35]
    v_mul_f32 v87, v56, v87
    v_mfma_f32_16x16x32_bf16 v[36:39], v[232:235], v[248:251], v[36:39]
    s_waitcnt lgkmcnt(0)
    s_barrier
    v_mfma_f32_16x16x32_bf16 v[40:43], v[228:231], v[252:255], v[40:43]
    v_mfma_f32_16x16x32_bf16 v[44:47], v[232:235], v[252:255], v[44:47]
    s_waitcnt lgkmcnt(0)
    v_mfma_f32_16x16x32_bf16 v[8:11], v[144:147], v[152:155], v[8:11]
    v_mfma_f32_16x16x32_bf16 v[12:15], v[148:151], v[152:155], v[12:15]
    v_mfma_f32_16x16x32_bf16 v[16:19], v[144:147], v[156:159], v[16:19]
    v_mfma_f32_16x16x32_bf16 v[20:23], v[148:151], v[156:159], v[20:23]
    v_mfma_f32_16x16x32_bf16 v[24:27], v[144:147], v[160:163], v[24:27]
    v_mfma_f32_16x16x32_bf16 v[28:31], v[148:151], v[160:163], v[28:31]
    v_mfma_f32_16x16x32_bf16 v[32:35], v[144:147], v[164:167], v[32:35]
    v_mfma_f32_16x16x32_bf16 v[36:39], v[148:151], v[164:167], v[36:39]
    v_mfma_f32_16x16x32_bf16 v[40:43], v[144:147], v[168:171], v[40:43]
    v_mfma_f32_16x16x32_bf16 v[44:47], v[148:151], v[168:171], v[44:47]
    v_mfma_f32_16x16x32_bf16 v[8:11], v[172:175], v[180:183], v[8:11]
    v_mfma_f32_16x16x32_bf16 v[12:15], v[176:179], v[180:183], v[12:15]
    v_mfma_f32_16x16x32_bf16 v[16:19], v[172:175], v[184:187], v[16:19]
    v_mfma_f32_16x16x32_bf16 v[20:23], v[176:179], v[184:187], v[20:23]
    v_mfma_f32_16x16x32_bf16 v[24:27], v[172:175], v[188:191], v[24:27]
    v_mfma_f32_16x16x32_bf16 v[28:31], v[176:179], v[188:191], v[28:31]
    v_mfma_f32_16x16x32_bf16 v[32:35], v[172:175], v[192:195], v[32:35]
    v_mfma_f32_16x16x32_bf16 v[36:39], v[176:179], v[192:195], v[36:39]
    v_mfma_f32_16x16x32_bf16 v[40:43], v[172:175], v[196:199], v[40:43]
    v_mfma_f32_16x16x32_bf16 v[44:47], v[176:179], v[196:199], v[44:47]
    s_setprio 2
    v_fma_f32 v53, v88, v8, v9
    v_fma_f32 v54, v92, v16, v17
    v_fma_f32 v55, v96, v24, v25
    s_nop 0
    v_fma_f32 v56, v100, v32, v33
    s_nop 0
    v_fma_f32 v57, v104, v40, v41
    v_fmac_f32_dpp v53, -v8, v89 quad_perm:[1,0,3,2] row_mask:0xf bank_mask:0xf
    v_fmac_f32_dpp v54, -v16, v93 quad_perm:[1,0,3,2] row_mask:0xf bank_mask:0xf
    v_fmac_f32_dpp v55, -v24, v97 quad_perm:[1,0,3,2] row_mask:0xf bank_mask:0xf
    v_fmac_f32_dpp v56, -v32, v101 quad_perm:[1,0,3,2] row_mask:0xf bank_mask:0xf
    v_fmac_f32_dpp v57, -v40, v105 quad_perm:[1,0,3,2] row_mask:0xf bank_mask:0xf
    v_fma_f32 v48, v88, v53, v10
    v_fma_f32 v49, v92, v54, v18
    v_fma_f32 v50, v96, v55, v26
    v_fma_f32 v51, v100, v56, v34
    v_fma_f32 v52, v104, v57, v42
    v_fmac_f32_dpp v48, -v53, v89 quad_perm:[1,0,3,2] row_mask:0xf bank_mask:0xf
    v_fmac_f32_dpp v49, -v54, v93 quad_perm:[1,0,3,2] row_mask:0xf bank_mask:0xf
    v_fmac_f32_dpp v50, -v55, v97 quad_perm:[1,0,3,2] row_mask:0xf bank_mask:0xf
    v_fmac_f32_dpp v51, -v56, v101 quad_perm:[1,0,3,2] row_mask:0xf bank_mask:0xf
    v_fmac_f32_dpp v52, -v57, v105 quad_perm:[1,0,3,2] row_mask:0xf bank_mask:0xf
    v_fma_f32 v53, v88, v48, v11
    v_fma_f32 v54, v92, v49, v19
    v_fma_f32 v55, v96, v50, v27
    v_fma_f32 v56, v100, v51, v35
    v_fma_f32 v57, v104, v52, v43
    v_fmac_f32_dpp v53, -v48, v89 quad_perm:[1,0,3,2] row_mask:0xf bank_mask:0xf
    v_fmac_f32_dpp v54, -v49, v93 quad_perm:[1,0,3,2] row_mask:0xf bank_mask:0xf
    v_fmac_f32_dpp v55, -v50, v97 quad_perm:[1,0,3,2] row_mask:0xf bank_mask:0xf
    v_fmac_f32_dpp v56, -v51, v101 quad_perm:[1,0,3,2] row_mask:0xf bank_mask:0xf
    v_fmac_f32_dpp v57, -v52, v105 quad_perm:[1,0,3,2] row_mask:0xf bank_mask:0xf
    v_fma_f32 v48, v88, v53, v12
    v_fma_f32 v49, v92, v54, v20
    v_fma_f32 v50, v96, v55, v28
    v_fma_f32 v51, v100, v56, v36
    v_fma_f32 v52, v104, v57, v44
    v_fmac_f32_dpp v48, -v53, v89 quad_perm:[1,0,3,2] row_mask:0xf bank_mask:0xf
    v_fmac_f32_dpp v49, -v54, v93 quad_perm:[1,0,3,2] row_mask:0xf bank_mask:0xf
    v_fmac_f32_dpp v50, -v55, v97 quad_perm:[1,0,3,2] row_mask:0xf bank_mask:0xf
    v_fmac_f32_dpp v51, -v56, v101 quad_perm:[1,0,3,2] row_mask:0xf bank_mask:0xf
    v_fmac_f32_dpp v52, -v57, v105 quad_perm:[1,0,3,2] row_mask:0xf bank_mask:0xf
    v_fma_f32 v53, v88, v48, v13
    v_fma_f32 v54, v92, v49, v21
    v_fma_f32 v55, v96, v50, v29
    v_fma_f32 v56, v100, v51, v37
    v_fma_f32 v57, v104, v52, v45
    v_fmac_f32_dpp v53, -v48, v89 quad_perm:[1,0,3,2] row_mask:0xf bank_mask:0xf
    v_fmac_f32_dpp v54, -v49, v93 quad_perm:[1,0,3,2] row_mask:0xf bank_mask:0xf
    v_fmac_f32_dpp v55, -v50, v97 quad_perm:[1,0,3,2] row_mask:0xf bank_mask:0xf
    v_fmac_f32_dpp v56, -v51, v101 quad_perm:[1,0,3,2] row_mask:0xf bank_mask:0xf
    v_fmac_f32_dpp v57, -v52, v105 quad_perm:[1,0,3,2] row_mask:0xf bank_mask:0xf
    v_fma_f32 v48, v88, v53, v14
    v_fma_f32 v49, v92, v54, v22
    v_fma_f32 v50, v96, v55, v30
    v_fma_f32 v51, v100, v56, v38
    v_fma_f32 v52, v104, v57, v46
    v_fmac_f32_dpp v48, -v53, v89 quad_perm:[1,0,3,2] row_mask:0xf bank_mask:0xf
    v_fmac_f32_dpp v49, -v54, v93 quad_perm:[1,0,3,2] row_mask:0xf bank_mask:0xf
    v_fmac_f32_dpp v50, -v55, v97 quad_perm:[1,0,3,2] row_mask:0xf bank_mask:0xf
    v_fmac_f32_dpp v51, -v56, v101 quad_perm:[1,0,3,2] row_mask:0xf bank_mask:0xf
    v_fmac_f32_dpp v52, -v57, v105 quad_perm:[1,0,3,2] row_mask:0xf bank_mask:0xf
    v_fma_f32 v53, v88, v48, v15
    v_fma_f32 v54, v92, v49, v23
    v_fma_f32 v55, v96, v50, v31
    v_fma_f32 v56, v100, v51, v39
    v_fma_f32 v57, v104, v52, v47
    v_fmac_f32_dpp v53, -v48, v89 quad_perm:[1,0,3,2] row_mask:0xf bank_mask:0xf
    v_fmac_f32_dpp v54, -v49, v93 quad_perm:[1,0,3,2] row_mask:0xf bank_mask:0xf
    v_fmac_f32_dpp v55, -v50, v97 quad_perm:[1,0,3,2] row_mask:0xf bank_mask:0xf
    v_fmac_f32_dpp v56, -v51, v101 quad_perm:[1,0,3,2] row_mask:0xf bank_mask:0xf
    v_fmac_f32_dpp v57, -v52, v105 quad_perm:[1,0,3,2] row_mask:0xf bank_mask:0xf
    v_mul_f32 v48, v78, v53
    v_mul_f32 v49, v80, v54
    v_mul_f32 v50, v82, v55
    v_mul_f32 v51, v84, v56
    v_mul_f32 v52, v86, v57
    v_fmac_f32_dpp v48, -v53, v79 quad_perm:[1,0,3,2] row_mask:0xf bank_mask:0xf
    v_fmac_f32_dpp v49, -v54, v81 quad_perm:[1,0,3,2] row_mask:0xf bank_mask:0xf
    v_fmac_f32_dpp v50, -v55, v83 quad_perm:[1,0,3,2] row_mask:0xf bank_mask:0xf
    v_fmac_f32_dpp v51, -v56, v85 quad_perm:[1,0,3,2] row_mask:0xf bank_mask:0xf
    v_fmac_f32_dpp v52, -v57, v87 quad_perm:[1,0,3,2] row_mask:0xf bank_mask:0xf
    v_mov_b32 v58, v52
    ds_write_b32 v108, v53 offset:320
    ds_write_b32 v108, v54 offset:384
    v_permlane32_swap_b32 v48, v49
    v_permlane32_swap_b32 v50, v51
    v_permlane32_swap_b32 v52, v58
    v_add_f32 v48, v48, v49
    v_add_f32 v50, v50, v51
    v_add_f32 v59, v52, v58
    v_add_f32 v52, v52, v58
    ds_write_b32 v108, v55 offset:448
    ds_write_b32 v108, v56 offset:512
    v_permlane16_swap_b32 v48, v50
    v_permlane16_swap_b32 v52, v59
    v_add_f32 v48, v48, v50
    v_add_f32 v52, v52, v59
    ds_write_b32 v108, v57 offset:576
    ds_write_b32 v72, v48
    ds_write_b32 v73, v52 offset:256
    v_mov_b32 v58, 1
    ds_write_b32 v3, v58
    s_mul_i32 s61, s4, 1280
    v_add_u32 v224, s61, v135
    v_min_u32 v174, s49, v0
    v_lshlrev_b32 v174, 7, v174
    s_mov_b32 s59, 0
Lw_44:
    ds_read_b128 v[68:71], v2 offset:16
    s_add_u32 s59, s59, 1
    s_waitcnt lgkmcnt(0)
    v_min_u32 v68, v68, v69
    v_min3_u32 v68, v68, v70, v71
    v_cmp_gt_u32 vcc, 1, v68
    s_cmp_gt_u32 s59, 1000000
    s_cbranch_scc1 Lx_45
    s_cbranch_vccnz Lw_44
Lx_45:
    ds_read_b64 v[64:65], v135 offset:5120
    ds_read_b64 v[66:67], v135 offset:10880
    ds_read_b64 v[68:69], v135 offset:16640
    ds_read_b64 v[60:61], v135 offset:22400
    ds_read_b64 v[218:219], v224 offset:0
    ds_read_b64 v[220:221], v224 offset:320
    ds_read_b64 v[222:223], v224 offset:640
    s_cmp_eq_u32 s4, 0
    s_cselect_b32 s72, s72, 1073741824
    s_waitcnt lgkmcnt(5)
    v_fmac_f32 v66, v115, v64
    v_fmac_f32 v67, v115, v65
    v_fmac_f32 v66, v117, v65
    v_fmac_f32 v67, v116, v64
    s_waitcnt lgkmcnt(3)
    v_fmac_f32 v68, v115, v66
    v_fmac_f32 v69, v115, v67
    v_fmac_f32 v68, v117, v67
    v_fmac_f32 v69, v116, v66
    v_fmac_f32 v60, v115, v68
    v_fmac_f32 v61, v115, v69
    v_fmac_f32 v60, v117, v69
    v_fmac_f32 v61, v116, v68
    s_mov_b32 exec_hi, 0xf
    buffer_store_dwordx4 v[60:63], v1, s[40:43], s72 offen sc1
    s_mov_b64 exec, -1
    buffer_load_dwordx2 v[172:173], v174, s[40:43], s51 offen sc1
    v_mov_b32 v216, 0
    v_mov_b32 v217, 0
    s_cmp_eq_u32 s4, 1
    s_cselect_b64 vcc, -1, 0
    v_cndmask_b32 v216, v216, v64, vcc
    v_cndmask_b32 v217, v217, v65, vcc
    s_cmp_eq_u32 s4, 2
    s_cselect_b64 vcc, -1, 0
    v_cndmask_b32 v216, v216, v66, vcc
    v_cndmask_b32 v217, v217, v67, vcc
    s_cmp_eq_u32 s4, 3
    s_cselect_b64 vcc, -1, 0
    v_cndmask_b32 v216, v216, v68, vcc
    v_cndmask_b32 v217, v217, v69, vcc
    v_lshlrev_b32 v6, 5, v5
    s_mov_b32 exec_lo, 0x01000100
    s_mov_b32 exec_hi, 0x01000100
    buffer_store_dwordx4 v[40:43], v6, s[40:43], s54 offen sc1
    buffer_store_dwordx4 v[44:47], v6, s[40:43], s54 offen offset:16 sc1
    s_mov_b64 exec, -1
    s_add_u32 m0, s48, 98304
    s_nop 0
    buffer_load_dwordx4 v1, s[40:43], s50 offen offset:0 sc1 lds
    v_mul_f32 v48, v90, v8
    v_mul_f32 v49, v90, v9
    v_mul_f32 v50, v90, v10
    buffer_load_dwordx4 v1, s[40:43], s50 offen offset:1024 sc1 lds
    v_mul_f32 v51, v90, v11
    v_mul_f32 v52, v90, v12
    v_mul_f32 v53, v90, v13
    buffer_load_dwordx4 v1, s[40:43], s50 offen offset:2048 sc1 lds
    v_mul_f32 v54, v90, v14
    v_mul_f32 v55, v90, v15
    v_fmac_f32_dpp v48, v8, v91 quad_perm:[1,0,3,2] row_mask:0xf bank_mask:0xf
    buffer_load_dwordx4 v1, s[40:43], s50 offen offset:3072 sc1 lds
    v_fmac_f32_dpp v49, v9, v91 quad_perm:[1,0,3,2] row_mask:0xf bank_mask:0xf
    v_fmac_f32_dpp v50, v10, v91 quad_perm:[1,0,3,2] row_mask:0xf bank_mask:0xf
    v_fmac_f32_dpp v51, v11, v91 quad_perm:[1,0,3,2] row_mask:0xf bank_mask:0xf
    s_add_u32 s50, s50, 16384
    s_add_u32 m0, s48, 114688
    s_nop 0
    buffer_load_dwordx4 v1, s[40:43], s50 offen offset:0 sc1 lds
    v_fmac_f32_dpp v52, v12, v91 quad_perm:[1,0,3,2] row_mask:0xf bank_mask:0xf
    v_fmac_f32_dpp v53, v13, v91 quad_perm:[1,0,3,2] row_mask:0xf bank_mask:0xf
    v_fmac_f32_dpp v54, v14, v91 quad_perm:[1,0,3,2] row_mask:0xf bank_mask:0xf
    buffer_load_dwordx4 v1, s[40:43], s50 offen offset:1024 sc1 lds
    v_fmac_f32_dpp v55, v15, v91 quad_perm:[1,0,3,2] row_mask:0xf bank_mask:0xf
    v_mul_f32 v56, v94, v16
    v_mul_f32 v57, v94, v17
    s_cmp_lt_u32 s4, 3
    s_cselect_b32 s50, s50, 1073741824
    s_cselect_b32 m0, m0, 163840
    s_nop 0
    buffer_load_dwordx4 v1, s[40:43], s50 offen offset:2048 sc1 lds
    v_mul_f32 v58, v94, v18
    v_mul_f32 v59, v94, v19
    v_mul_f32 v60, v94, v20
    buffer_load_dwordx4 v1, s[40:43], s50 offen offset:3072 sc1 lds
    v_mul_f32 v61, v94, v21
    v_mul_f32 v62, v94, v22
    v_mul_f32 v63, v94, v23
    s_add_u32 s50, s50, 16384
    s_mov_b32 s10, 2359296
    s_mov_b32 s11, 0x20000
    s_mov_b32 s38, 4718592
    s_mov_b32 s39, 0x20000
    v_add_u32 v252, s57, v1
    v_add_u32 v253, 640, v252
    v_add_u32 v254, 1280, v252
    v_add_u32 v255, 1920, v252
    s_mov_b32 exec_hi, 0xf
    buffer_load_dwordx4 v[236:239], v252, s[28:31], 0 offen sc1
    buffer_load_dwordx4 v[240:243], v253, s[28:31], 0 offen sc1
    buffer_load_dwordx4 v[244:247], v254, s[28:31], 0 offen sc1
    buffer_load_dwordx4 v[248:251], v255, s[28:31], 0 offen sc1
    s_mov_b64 exec, -1
    s_mov_b32 s59, 0
    s_waitcnt vmcnt(14)
    s_branch Lr_49
Lp_47:
    s_sleep 4
    buffer_load_dwordx2 v[172:173], v174, s[40:43], s51 offen sc1
    s_waitcnt vmcnt(0)
Lr_49:
    s_add_u32 s59, s59, 1
    v_cmp_ne_u64 vcc, s[100:101], v[172:173]
    s_cmp_gt_u32 s59, 100000
    s_cbranch_scc1 Lq_48
    s_cbranch_vccnz Lp_47
Lq_48:
    v_mov_b32 v225, 2
    ds_write_b32 v3, v225
    v_fmac_f32_dpp v56, v16, v95 quad_perm:[1,0,3,2] row_mask:0xf bank_mask:0xf
    v_fmac_f32_dpp v57, v17, v95 quad_perm:[1,0,3,2] row_mask:0xf bank_mask:0xf
    v_fmac_f32_dpp v58, v18, v95 quad_perm:[1,0,3,2] row_mask:0xf bank_mask:0xf
    v_fmac_f32_dpp v59, v19, v95 quad_perm:[1,0,3,2] row_mask:0xf bank_mask:0xf
    v_fmac_f32_dpp v60, v20, v95 quad_perm:[1,0,3,2] row_mask:0xf bank_mask:0xf
    v_fmac_f32_dpp v61, v21, v95 quad_perm:[1,0,3,2] row_mask:0xf bank_mask:0xf
    v_fmac_f32_dpp v62, v22, v95 quad_perm:[1,0,3,2] row_mask:0xf bank_mask:0xf
    v_fmac_f32_dpp v63, v23, v95 quad_perm:[1,0,3,2] row_mask:0xf bank_mask:0xf
    ds_read_b128 v[228:231], v2 offset:16
    v_mul_f32 v64, v98, v24
    v_mul_f32 v65, v98, v25
    v_mul_f32 v66, v98, v26
    v_mul_f32 v67, v98, v27
    v_mul_f32 v68, v98, v28
    v_mul_f32 v69, v98, v29
    v_mul_f32 v70, v98, v30
    v_mul_f32 v71, v98, v31
    s_waitcnt lgkmcnt(0)
    v_min_u32 v228, v228, v229
    v_min3_u32 v228, v228, v230, v231
    v_cmp_gt_u32 vcc, 2, v228
    s_cbranch_vccz Lk_50
    s_mov_b32 s59, 0
    s_branch Le_53
Lw_51:
    s_sleep 1
Le_53:
    ds_read_b128 v[228:231], v2 offset:16
    s_add_u32 s59, s59, 1
    s_waitcnt lgkmcnt(0)
    v_min_u32 v228, v228, v229
    v_min3_u32 v228, v228, v230, v231
    v_cmp_gt_u32 vcc, 2, v228
    s_cmp_gt_u32 s59, 1000000
    s_cbranch_scc1 Lx_52
    s_cbranch_vccnz Lw_51
Lx_52:
Lk_50:
    buffer_load_dwordx4 v[136:139], v1, s[40:43], s66 offen offset:0 sc1
    v_fmac_f32_dpp v64, v24, v99 quad_perm:[1,0,3,2] row_mask:0xf bank_mask:0xf
    v_fmac_f32_dpp v65, v25, v99 quad_perm:[1,0,3,2] row_mask:0xf bank_mask:0xf
    v_fmac_f32_dpp v66, v26, v99 quad_perm:[1,0,3,2] row_mask:0xf bank_mask:0xf
    v_fmac_f32_dpp v67, v27, v99 quad_perm:[1,0,3,2] row_mask:0xf bank_mask:0xf
    buffer_load_dwordx4 v[140:143], v1, s[40:43], s66 offen offset:1024 sc1
    v_fmac_f32_dpp v68, v28, v99 quad_perm:[1,0,3,2] row_mask:0xf bank_mask:0xf
    v_fmac_f32_dpp v69, v29, v99 quad_perm:[1,0,3,2] row_mask:0xf bank_mask:0xf
    v_fmac_f32_dpp v70, v30, v99 quad_perm:[1,0,3,2] row_mask:0xf bank_mask:0xf
    v_fmac_f32_dpp v71, v31, v99 quad_perm:[1,0,3,2] row_mask:0xf bank_mask:0xf
    buffer_load_dwordx4 v[144:147], v1, s[40:43], s66 offen offset:2048 sc1
    v_mul_f32 v72, v102, v32
    v_mul_f32 v73, v102, v33
    v_mul_f32 v74, v102, v34
    v_mul_f32 v75, v102, v35
    buffer_load_dwordx4 v[148:151], v1, s[40:43], s66 offen offset:3072 sc1
    v_mul_f32 v76, v102, v36
    v_mul_f32 v77, v102, v37
    v_mul_f32 v78, v102, v38
    v_mul_f32 v79, v102, v39
    buffer_load_dwordx4 v[152:155], v110, s[40:43], s66 offen sc1
    v_fmac_f32_dpp v72, v32, v103 quad_perm:[1,0,3,2] row_mask:0xf bank_mask:0xf
    v_fmac_f32_dpp v73, v33, v103 quad_perm:[1,0,3,2] row_mask:0xf bank_mask:0xf
    v_fmac_f32_dpp v74, v34, v103 quad_perm:[1,0,3,2] row_mask:0xf bank_mask:0xf
    v_fmac_f32_dpp v75, v35, v103 quad_perm:[1,0,3,2] row_mask:0xf bank_mask:0xf
    s_add_u32 s66, s66, 4608
    v_fmac_f32_dpp v76, v36, v103 quad_perm:[1,0,3,2] row_mask:0xf bank_mask:0xf
    v_fmac_f32_dpp v77, v37, v103 quad_perm:[1,0,3,2] row_mask:0xf bank_mask:0xf
    v_fmac_f32_dpp v78, v38, v103 quad_perm:[1,0,3,2] row_mask:0xf bank_mask:0xf
    v_fmac_f32_dpp v79, v39, v103 quad_perm:[1,0,3,2] row_mask:0xf bank_mask:0xf
    buffer_load_dwordx4 v[156:159], v1, s[40:43], s66 offen offset:0 sc1
    v_mul_f32 v80, v106, v40
    v_mul_f32 v81, v106, v41
    v_mul_f32 v82, v106, v42
    v_mul_f32 v83, v106, v43
    buffer_load_dwordx4 v[160:163], v1, s[40:43], s66 offen offset:1024 sc1
    v_mul_f32 v84, v106, v44
    v_mul_f32 v85, v106, v45
    v_mul_f32 v86, v106, v46
    v_mul_f32 v87, v106, v47
    buffer_load_dwordx4 v[164:167], v1, s[40:43], s66 offen offset:2048 sc1
    v_fmac_f32_dpp v80, v40, v107 quad_perm:[1,0,3,2] row_mask:0xf bank_mask:0xf
    v_fmac_f32_dpp v81, v41, v107 quad_perm:[1,0,3,2] row_mask:0xf bank_mask:0xf
    v_fmac_f32_dpp v82, v42, v107 quad_perm:[1,0,3,2] row_mask:0xf bank_mask:0xf
    v_fmac_f32_dpp v83, v43, v107 quad_perm:[1,0,3,2] row_mask:0xf bank_mask:0xf
    buffer_load_dwordx4 v[168:171], v1, s[40:43], s66 offen offset:3072 sc1
    v_fmac_f32_dpp v84, v44, v107 quad_perm:[1,0,3,2] row_mask:0xf bank_mask:0xf
    v_fmac_f32_dpp v85, v45, v107 quad_perm:[1,0,3,2] row_mask:0xf bank_mask:0xf
    v_fmac_f32_dpp v86, v46, v107 quad_perm:[1,0,3,2] row_mask:0xf bank_mask:0xf
    v_fmac_f32_dpp v87, v47, v107 quad_perm:[1,0,3,2] row_mask:0xf bank_mask:0xf
    buffer_load_dwordx4 v[172:175], v110, s[40:43], s66 offen sc1
    s_add_u32 s66, s66, 4608
    s_mul_i32 s61, s4, 288
    v_add_u32 v38, s61, v135
    s_mov_b32 s62, 0
    s_mov_b32 exec_hi, 0xf
    s_waitcnt vmcnt(10)
    s_branch L_eg0
L_eg:
    s_sleep 2
    s_mov_b32 exec_hi, 0xf
    buffer_load_dwordx4 v[236:239], v252, s[28:31], 0 offen sc1
    buffer_load_dwordx4 v[240:243], v253, s[28:31], 0 offen sc1
    buffer_load_dwordx4 v[244:247], v254, s[28:31], 0 offen sc1
    buffer_load_dwordx4 v[248:251], v255, s[28:31], 0 offen sc1
    s_waitcnt vmcnt(0)
L_eg0:
    s_add_u32 s62, s62, 1
    s_mov_b32 s63, 0
    v_cmp_ne_u64 vcc, s[100:101], v[238:239]
    s_cmp_eq_u64 vcc, 0
    s_addc_u32 s63, s63, 0
    v_cmp_ne_u64 vcc, s[100:101], v[242:243]
    v_fmac_f32 v240, v122, v236
    v_fmac_f32 v241, v122, v237
    v_fmac_f32 v240, v124, v237
    v_fmac_f32 v241, v123, v236
    s_cmp_eq_u64 vcc, 0
    s_addc_u32 s63, s63, 0
    v_cmp_ne_u64 vcc, s[100:101], v[246:247]
    v_fmac_f32 v244, v122, v240
    v_fmac_f32 v245, v122, v241
    v_fmac_f32 v244, v124, v241
    v_fmac_f32 v245, v123, v240
    s_cmp_eq_u64 vcc, 0
    s_addc_u32 s63, s63, 0
    v_cmp_ne_u64 vcc, s[100:101], v[250:251]
    v_fmac_f32 v248, v122, v244
    v_fmac_f32 v249, v122, v245
    v_fmac_f32 v248, v124, v245
    v_fmac_f32 v249, v123, v244
    s_cmp_eq_u64 vcc, 0
    s_addc_u32 s63, s63, 0
    v_mul_f32 v28, v125, v248
    v_mul_f32 v29, v125, v249
    v_fmac_f32 v28, v127, v249
    v_fmac_f32 v29, v126, v248
    s_cmp_gt_u32 s62, 12500
    s_cbranch_scc1 L_egx
    s_cmp_lt_u32 s63, s65
    s_cbranch_scc1 L_eg
L_egx:
    ds_write_b64 v38, v[28:29] offset:32960
    v_mov_b32 v30, 3
    ds_write_b32 v3, v30
    s_mov_b32 s59, 0
Lw_54:
    ds_read_b128 v[28:31], v2 offset:16
    s_add_u32 s59, s59, 1
    s_waitcnt lgkmcnt(0)
    v_min_u32 v28, v28, v29
    v_min3_u32 v28, v28, v30, v31
    v_cmp_gt_u32 vcc, 3, v28
    s_cmp_gt_u32 s59, 1000000
    s_cbranch_scc1 Lx_55
    s_cbranch_vccnz Lw_54
Lx_55:
    ds_read_b64 v[8:9], v135 offset:32960
    ds_read_b64 v[10:11], v135 offset:33248
    ds_read_b64 v[12:13], v135 offset:33536
    ds_read_b64 v[14:15], v135 offset:33824
    s_waitcnt lgkmcnt(2)
    v_add_f32 v8, v8, v10
    v_add_f32 v9, v9, v11
    s_waitcnt lgkmcnt(0)
    v_add_f32 v12, v12, v14
    v_add_f32 v13, v13, v15
    v_add_f32 v8, v8, v12
    v_add_f32 v9, v9, v13
    v_fmac_f32 v216, v118, v8
    v_fmac_f32 v217, v118, v9
    v_fmac_f32 v216, v120, v9
    v_fmac_f32 v217, v119, v8
    ds_write_b64 v224, v[216:217]
    v_fmac_f32 v218, v112, v216
    v_fmac_f32 v219, v112, v217
    v_fmac_f32 v218, v114, v217
    v_fmac_f32 v219, v113, v216
    ds_write_b64 v224, v[218:219] offset:320
    v_fmac_f32 v220, v112, v218
    v_fmac_f32 v221, v112, v219
    v_fmac_f32 v220, v114, v219
    v_fmac_f32 v221, v113, v218
    ds_write_b64 v224, v[220:221] offset:640
    v_fmac_f32 v222, v112, v220
    v_fmac_f32 v223, v112, v221
    v_fmac_f32 v222, v114, v221
    v_fmac_f32 v223, v113, v220
    ds_write_b64 v224, v[222:223] offset:960
    s_mov_b64 exec, -1
    ds_read_b32 v40, v108 offset:320
    ds_read_b32 v41, v108 offset:384
    ds_read_b32 v42, v108 offset:448
    ds_read_b32 v43, v108 offset:512
    ds_read_b32 v44, v108 offset:576
    s_setprio 2
    s_waitcnt lgkmcnt(0)
    v_mul_f32 v32, v90, v40
    v_mul_f32 v33, v94, v41
    v_mul_f32 v34, v98, v42
    v_mul_f32 v35, v102, v43
    v_mul_f32 v36, v106, v44
    v_fmac_f32_dpp v32, v40, v91 quad_perm:[1,0,3,2] row_mask:0xf bank_mask:0xf
    v_fmac_f32_dpp v33, v41, v95 quad_perm:[1,0,3,2] row_mask:0xf bank_mask:0xf
    v_fmac_f32_dpp v34, v42, v99 quad_perm:[1,0,3,2] row_mask:0xf bank_mask:0xf
    v_fmac_f32_dpp v35, v43, v103 quad_perm:[1,0,3,2] row_mask:0xf bank_mask:0xf
    v_fmac_f32_dpp v36, v44, v107 quad_perm:[1,0,3,2] row_mask:0xf bank_mask:0xf
    v_fmac_f32 v48, v88, v32
    v_fmac_f32 v56, v92, v33
    v_fmac_f32 v64, v96, v34
    v_fmac_f32 v72, v100, v35
    v_fmac_f32 v80, v104, v36
    buffer_load_dwordx4 v[176:179], v1, s[40:43], s66 offen offset:0 sc1
    v_fmac_f32_dpp v48, v32, v89 quad_perm:[1,0,3,2] row_mask:0xf bank_mask:0xf
    v_fmac_f32_dpp v56, v33, v93 quad_perm:[1,0,3,2] row_mask:0xf bank_mask:0xf
    v_fmac_f32_dpp v64, v34, v97 quad_perm:[1,0,3,2] row_mask:0xf bank_mask:0xf
    v_fmac_f32_dpp v72, v35, v101 quad_perm:[1,0,3,2] row_mask:0xf bank_mask:0xf
    v_fmac_f32_dpp v80, v36, v105 quad_perm:[1,0,3,2] row_mask:0xf bank_mask:0xf
    buffer_load_dwordx4 v[180:183], v1, s[40:43], s66 offen offset:1024 sc1
    v_fmac_f32 v49, v88, v48
    v_fmac_f32 v57, v92, v56
    v_fmac_f32 v65, v96, v64
    v_fmac_f32 v73, v100, v72
    v_fmac_f32 v81, v104, v80
    buffer_load_dwordx4 v[184:187], v1, s[40:43], s66 offen offset:2048 sc1
    v_fmac_f32_dpp v49, v48, v89 quad_perm:[1,0,3,2] row_mask:0xf bank_mask:0xf
    v_fmac_f32_dpp v57, v56, v93 quad_perm:[1,0,3,2] row_mask:0xf bank_mask:0xf
    v_fmac_f32_dpp v65, v64, v97 quad_perm:[1,0,3,2] row_mask:0xf bank_mask:0xf
    v_fmac_f32_dpp v73, v72, v101 quad_perm:[1,0,3,2] row_mask:0xf bank_mask:0xf
    v_fmac_f32_dpp v81, v80, v105 quad_perm:[1,0,3,2] row_mask:0xf bank_mask:0xf
    buffer_load_dwordx4 v[188:191], v1, s[40:43], s66 offen offset:3072 sc1
    v_fmac_f32 v50, v88, v49
    v_fmac_f32 v58, v92, v57
    v_fmac_f32 v66, v96, v65
    v_fmac_f32 v74, v100, v73
    v_fmac_f32 v82, v104, v81
    buffer_load_dwordx4 v[192:195], v110, s[40:43], s66 offen sc1
    v_fmac_f32_dpp v50, v49, v89 quad_perm:[1,0,3,2] row_mask:0xf bank_mask:0xf
    v_fmac_f32_dpp v58, v57, v93 quad_perm:[1,0,3,2] row_mask:0xf bank_mask:0xf
    v_fmac_f32_dpp v66, v65, v97 quad_perm:[1,0,3,2] row_mask:0xf bank_mask:0xf
    v_fmac_f32_dpp v74, v73, v101 quad_perm:[1,0,3,2] row_mask:0xf bank_mask:0xf
    v_fmac_f32_dpp v82, v81, v105 quad_perm:[1,0,3,2] row_mask:0xf bank_mask:0xf
    s_add_u32 s66, s66, 4608
    v_fmac_f32 v51, v88, v50
    v_fmac_f32 v59, v92, v58
    v_fmac_f32 v67, v96, v66
    v_fmac_f32 v75, v100, v74
    v_fmac_f32 v83, v104, v82
    buffer_load_dwordx4 v[196:199], v1, s[40:43], s66 offen offset:0 sc1
    v_fmac_f32_dpp v51, v50, v89 quad_perm:[1,0,3,2] row_mask:0xf bank_mask:0xf
    v_fmac_f32_dpp v59, v58, v93 quad_perm:[1,0,3,2] row_mask:0xf bank_mask:0xf
    v_fmac_f32_dpp v67, v66, v97 quad_perm:[1,0,3,2] row_mask:0xf bank_mask:0xf
    v_fmac_f32_dpp v75, v74, v101 quad_perm:[1,0,3,2] row_mask:0xf bank_mask:0xf
    v_fmac_f32_dpp v83, v82, v105 quad_perm:[1,0,3,2] row_mask:0xf bank_mask:0xf
    buffer_load_dwordx4 v[200:203], v1, s[40:43], s66 offen offset:1024 sc1
    v_fmac_f32 v52, v88, v51
    v_fmac_f32 v60, v92, v59
    v_fmac_f32 v68, v96, v67
    v_fmac_f32 v76, v100, v75
    v_fmac_f32 v84, v104, v83
    buffer_load_dwordx4 v[204:207], v1, s[40:43], s66 offen offset:2048 sc1
    v_fmac_f32_dpp v52, v51, v89 quad_perm:[1,0,3,2] row_mask:0xf bank_mask:0xf
    v_fmac_f32_dpp v60, v59, v93 quad_perm:[1,0,3,2] row_mask:0xf bank_mask:0xf
    v_fmac_f32_dpp v68, v67, v97 quad_perm:[1,0,3,2] row_mask:0xf bank_mask:0xf
    v_fmac_f32_dpp v76, v75, v101 quad_perm:[1,0,3,2] row_mask:0xf bank_mask:0xf
    v_fmac_f32_dpp v84, v83, v105 quad_perm:[1,0,3,2] row_mask:0xf bank_mask:0xf
    buffer_load_dwordx4 v[208:211], v1, s[40:43], s66 offen offset:3072 sc1
    v_fmac_f32 v53, v88, v52
    v_fmac_f32 v61, v92, v60
    v_fmac_f32 v69, v96, v68
    v_fmac_f32 v77, v100, v76
    v_fmac_f32 v85, v104, v84
    buffer_load_dwordx4 v[212:215], v110, s[40:43], s66 offen sc1
    v_fmac_f32_dpp v53, v52, v89 quad_perm:[1,0,3,2] row_mask:0xf bank_mask:0xf
    v_fmac_f32_dpp v61, v60, v93 quad_perm:[1,0,3,2] row_mask:0xf bank_mask:0xf
    v_fmac_f32_dpp v69, v68, v97 quad_perm:[1,0,3,2] row_mask:0xf bank_mask:0xf
    v_fmac_f32_dpp v77, v76, v101 quad_perm:[1,0,3,2] row_mask:0xf bank_mask:0xf
    v_fmac_f32_dpp v85, v84, v105 quad_perm:[1,0,3,2] row_mask:0xf bank_mask:0xf
    s_add_u32 s66, s66, 4608
    v_fmac_f32 v54, v88, v53
    v_fmac_f32 v62, v92, v61
    v_fmac_f32 v70, v96, v69
    v_fmac_f32 v78, v100, v77
    v_fmac_f32 v86, v104, v85
    v_fmac_f32_dpp v54, v53, v89 quad_perm:[1,0,3,2] row_mask:0xf bank_mask:0xf
    v_fmac_f32_dpp v62, v61, v93 quad_perm:[1,0,3,2] row_mask:0xf bank_mask:0xf
    v_fmac_f32_dpp v70, v69, v97 quad_perm:[1,0,3,2] row_mask:0xf bank_mask:0xf
    v_fmac_f32_dpp v78, v77, v101 quad_perm:[1,0,3,2] row_mask:0xf bank_mask:0xf
    v_fmac_f32_dpp v86, v85, v105 quad_perm:[1,0,3,2] row_mask:0xf bank_mask:0xf
    v_fmac_f32 v55, v88, v54
    v_fmac_f32 v63, v92, v62
    v_fmac_f32 v71, v96, v70
    v_fmac_f32 v79, v100, v78
    v_fmac_f32 v87, v104, v86
    v_fmac_f32_dpp v55, v54, v89 quad_perm:[1,0,3,2] row_mask:0xf bank_mask:0xf
    v_fmac_f32_dpp v63, v62, v93 quad_perm:[1,0,3,2] row_mask:0xf bank_mask:0xf
    v_fmac_f32_dpp v71, v70, v97 quad_perm:[1,0,3,2] row_mask:0xf bank_mask:0xf
    v_fmac_f32_dpp v79, v78, v101 quad_perm:[1,0,3,2] row_mask:0xf bank_mask:0xf
    v_fmac_f32_dpp v87, v86, v105 quad_perm:[1,0,3,2] row_mask:0xf bank_mask:0xf
    v_cvt_pk_bf16_f32 v8, v48, v49
    v_cvt_pk_bf16_f32 v9, v50, v51
    v_cvt_pk_bf16_f32 v10, v52, v53
    v_cvt_pk_bf16_f32 v11, v54, v55
    ds_write_b128 v109, v[8:11] offset:0
    v_cvt_pk_bf16_f32 v12, v56, v57
    v_cvt_pk_bf16_f32 v13, v58, v59
    v_cvt_pk_bf16_f32 v14, v60, v61
    v_cvt_pk_bf16_f32 v15, v62, v63
    ds_write_b128 v109, v[12:15] offset:1280
    v_cvt_pk_bf16_f32 v16, v64, v65
    v_cvt_pk_bf16_f32 v17, v66, v67
    v_cvt_pk_bf16_f32 v18, v68, v69
    v_cvt_pk_bf16_f32 v19, v70, v71
    ds_write_b128 v109, v[16:19] offset:2560
    v_cvt_pk_bf16_f32 v20, v72, v73
    v_cvt_pk_bf16_f32 v21, v74, v75
    v_cvt_pk_bf16_f32 v22, v76, v77
    v_cvt_pk_bf16_f32 v23, v78, v79
    ds_write_b128 v109, v[20:23] offset:3840
    v_cvt_pk_bf16_f32 v24, v80, v81
    v_cvt_pk_bf16_f32 v25, v82, v83
    v_cvt_pk_bf16_f32 v26, v84, v85
    v_cvt_pk_bf16_f32 v27, v86, v87
    s_mov_b32 exec_lo, 0x00ff00ff
    s_mov_b32 exec_hi, 0x00ff00ff
    ds_write_b128 v109, v[24:27] offset:5120
    s_mov_b64 exec, -1
    ds_read_b64_tr_b16 v[88:89], v128
    ds_read_b64_tr_b16 v[90:91], v128 offset:80
    ds_read_b64_tr_b16 v[92:93], v129
    ds_read_b64_tr_b16 v[94:95], v129 offset:80
    ds_read_b64_tr_b16 v[96:97], v130
    ds_read_b64_tr_b16 v[98:99], v130 offset:80
    ds_read_b64_tr_b16 v[100:101], v131
    ds_read_b64_tr_b16 v[102:103], v131 offset:80
    ds_read_b64_tr_b16 v[104:105], v132
    ds_read_b64_tr_b16 v[106:107], v132 offset:80
    ds_read_b128 v[28:31], v2 offset:0
    s_waitcnt lgkmcnt(9)
    buffer_store_dwordx4 v[88:91], v1, s[40:43], s55 offen offset:0 sc1
    s_waitcnt lgkmcnt(7)
    buffer_store_dwordx4 v[92:95], v1, s[40:43], s55 offen offset:1024 sc1
    s_waitcnt lgkmcnt(5)
    buffer_store_dwordx4 v[96:99], v133, s[40:43], s55 offen offset:2048 sc1
    s_waitcnt lgkmcnt(3)
    buffer_store_dwordx4 v[100:103], v134, s[40:43], s55 offen offset:3072 sc1
    s_waitcnt lgkmcnt(1)
    s_mov_b32 exec_hi, 0
    s_add_u32 s55, s55, 4096
    buffer_store_dwordx4 v[104:107], v134, s[40:43], s55 offen offset:0 sc1
    s_mov_b64 exec, -1
    s_setprio 0
    v_mov_b32 v124, s100
    v_mov_b32 v125, s101
    v_lshlrev_b32 v126, 9, v0
    v_mov_b32 v7, v110
    s_mul_i32 s62, s44, 147456
    s_mul_i32 s63, s4, 9216
    s_add_u32 s62, s62, s63
    s_add_u32 s68, s62, 4055040
    s_add_u32 s69, s68, 36864
    s_add_u32 s70, s69, 36864
    s_add_u32 s71, s70, 36864
    s_add_u32 s53, s64, 165888
    s_add_u32 s53, s53, s48
    buffer_load_dwordx4 v[216:219], v1, s[40:43], s66 offen offset:0 sc1
    buffer_load_dwordx4 v[220:223], v1, s[40:43], s66 offen offset:1024 sc1
    buffer_load_dwordx4 v[224:227], v1, s[40:43], s66 offen offset:2048 sc1
    buffer_load_dwordx4 v[228:231], v1, s[40:43], s66 offen offset:3072 sc1
    buffer_load_dwordx4 v[232:235], v110, s[40:43], s66 offen sc1
    s_add_u32 s66, s66, 4608
    buffer_load_dwordx4 v[236:239], v1, s[40:43], s66 offen offset:0 sc1
    buffer_load_dwordx4 v[240:243], v1, s[40:43], s66 offen offset:1024 sc1
    buffer_load_dwordx4 v[244:247], v1, s[40:43], s66 offen offset:2048 sc1
    buffer_load_dwordx4 v[248:251], v1, s[40:43], s66 offen offset:3072 sc1
    buffer_load_dwordx4 v[252:255], v110, s[40:43], s66 offen sc1
    s_add_u32 s66, s66, 4608
    s_mov_b64 exec, 0xff
    s_waitcnt vmcnt(10)
    buffer_store_dwordx2 v[124:125], v126, s[40:43], s75 offen sc1
    s_mov_b64 exec, -1
    s_waitcnt lgkmcnt(0)
    v_min_u32 v28, v28, v29
    v_min3_u32 v28, v28, v30, v31
    v_cmp_gt_u32 vcc, 4, v28
    s_cbranch_vccz Lk_57
    s_mov_b32 s59, 0
    s_branch Le_60
Lw_58:
    s_sleep 1
Le_60:
    ds_read_b128 v[28:31], v2 offset:0
    s_add_u32 s59, s59, 1
    s_waitcnt lgkmcnt(0)
    v_min_u32 v28, v28, v29
    v_min3_u32 v28, v28, v30, v31
    v_cmp_gt_u32 vcc, 4, v28
    s_cmp_gt_u32 s59, 1000000
    s_cbranch_scc1 Lx_59
    s_cbranch_vccnz Lw_58
Lx_59:
Lk_57:
    s_add_u32 m0, s48, 81920
    s_add_u32 s61, s53, 81920
    s_cmp_eq_u32 s4, 0
    s_cselect_b32 m0, m0, 163840
    s_cselect_b32 s61, s61, 1073741824
    buffer_load_dwordx4 v1, s[40:43], s61 offen offset:0 sc1 lds
    s_add_u32 m0, s48, 65536
    s_add_u32 s61, s53, 65536
    buffer_load_dwordx4 v1, s[40:43], s61 offen offset:0 sc1 lds
    buffer_load_dwordx4 v1, s[40:43], s61 offen offset:1024 sc1 lds
    buffer_load_dwordx4 v1, s[40:43], s61 offen offset:2048 sc1 lds
    buffer_load_dwordx4 v1, s[40:43], s61 offen offset:3072 sc1 lds
    s_add_u32 m0, s48, 49152
    s_add_u32 s61, s53, 49152
    buffer_load_dwordx4 v1, s[40:43], s61 offen offset:0 sc1 lds
    buffer_load_dwordx4 v1, s[40:43], s61 offen offset:1024 sc1 lds
    buffer_load_dwordx4 v1, s[40:43], s61 offen offset:2048 sc1 lds
    buffer_load_dwordx4 v1, s[40:43], s61 offen offset:3072 sc1 lds
    s_mov_b32 s59, 0
    s_branch Lv_63
Ls_61:
    s_sleep 2
Lv_63:
    s_load_dwordx8 s[28:35], s[18:19], 0 glc
    s_load_dwordx8 s[48:55], s[18:19], 128 glc
    s_load_dwordx2 s[26:27], s[14:15], 0 glc
    s_add_u32 s59, s59, 1
    s_cmp_gt_u32 s59, 100000
    s_cbranch_scc1 Lt_62
    s_waitcnt lgkmcnt(0)
    s_xor_b64 s[28:29], s[28:29], s[100:101]
    s_xor_b64 s[30:31], s[30:31], s[100:101]
    s_xor_b64 s[32:33], s[32:33], s[100:101]
    s_xor_b64 s[34:35], s[34:35], s[100:101]
    s_xor_b64 s[48:49], s[48:49], s[100:101]
    s_xor_b64 s[50:51], s[50:51], s[100:101]
    s_xor_b64 s[52:53], s[52:53], s[100:101]
    s_xor_b64 s[54:55], s[54:55], s[100:101]
    s_xor_b64 s[26:27], s[26:27], s[100:101]
    s_or_b64 s[28:29], s[28:29], s[30:31]
    s_or_b64 s[28:29], s[28:29], s[32:33]
    s_or_b64 s[28:29], s[28:29], s[34:35]
    s_or_b64 s[28:29], s[28:29], s[48:49]
    s_or_b64 s[28:29], s[28:29], s[50:51]
    s_or_b64 s[28:29], s[28:29], s[52:53]
    s_or_b64 s[28:29], s[28:29], s[54:55]
    s_or_b64 s[28:29], s[28:29], s[26:27]
    s_cbranch_scc1 Ls_61
Lt_62:
    s_waitcnt lgkmcnt(0)
    buffer_load_dwordx4 v[88:91], v1, s[40:43], s68 offen offset:0 sc1
    buffer_load_dwordx4 v[92:95], v1, s[40:43], s69 offen offset:0 sc1
    buffer_load_dwordx4 v[96:99], v1, s[40:43], s70 offen offset:0 sc1
    buffer_load_dwordx4 v[100:103], v1, s[40:43], s71 offen offset:0 sc1
    buffer_load_dwordx4 v[104:107], v1, s[40:43], s68 offen offset:1024 sc1
    buffer_load_dwordx4 v[108:111], v1, s[40:43], s69 offen offset:1024 sc1
    buffer_load_dwordx4 v[112:115], v1, s[40:43], s70 offen offset:1024 sc1
    buffer_load_dwordx4 v[116:119], v1, s[40:43], s71 offen offset:1024 sc1
    s_waitcnt vmcnt(8)
    v_mov_b32 v6, 4
    ds_write_b32 v3, v6
    buffer_load_dwordx4 v[120:123], v1, s[40:43], s68 offen offset:2048 sc1
    buffer_load_dwordx4 v[124:127], v1, s[40:43], s69 offen offset:2048 sc1
    buffer_load_dwordx4 v[128:131], v1, s[40:43], s70 offen offset:2048 sc1
    buffer_load_dwordx4 v[132:135], v1, s[40:43], s71 offen offset:2048 sc1
    s_waitcnt vmcnt(11)
    v_mfma_f32_16x16x32_bf16 v[8:11], v[136:139], v[88:91], 0
    v_mfma_f32_16x16x32_bf16 v[12:15], v[140:143], v[88:91], 0
    v_mfma_f32_16x16x32_bf16 v[16:19], v[144:147], v[88:91], 0
    v_mfma_f32_16x16x32_bf16 v[20:23], v[148:151], v[88:91], 0
    v_mfma_f32_16x16x32_bf16 v[24:27], v[152:155], v[88:91], 0
    buffer_load_dwordx4 v[88:91], v1, s[40:43], s68 offen offset:3072 sc1
    s_waitcnt vmcnt(11)
    v_mfma_f32_16x16x32_bf16 v[28:31], v[136:139], v[92:95], 0
    v_mfma_f32_16x16x32_bf16 v[32:35], v[140:143], v[92:95], 0
    v_mfma_f32_16x16x32_bf16 v[36:39], v[144:147], v[92:95], 0
    v_mfma_f32_16x16x32_bf16 v[40:43], v[148:151], v[92:95], 0
    v_mfma_f32_16x16x32_bf16 v[44:47], v[152:155], v[92:95], 0
    buffer_load_dwordx4 v[92:95], v1, s[40:43], s69 offen offset:3072 sc1
    s_waitcnt vmcnt(11)
    v_mfma_f32_16x16x32_bf16 v[48:51], v[136:139], v[96:99], 0
    v_mfma_f32_16x16x32_bf16 v[52:55], v[140:143], v[96:99], 0
    v_mfma_f32_16x16x32_bf16 v[56:59], v[144:147], v[96:99], 0
    v_mfma_f32_16x16x32_bf16 v[60:63], v[148:151], v[96:99], 0
    v_mfma_f32_16x16x32_bf16 v[64:67], v[152:155], v[96:99], 0
    buffer_load_dwordx4 v[96:99], v1, s[40:43], s70 offen offset:3072 sc1
    s_waitcnt vmcnt(11)
    v_mfma_f32_16x16x32_bf16 v[68:71], v[136:139], v[100:103], 0
    v_mfma_f32_16x16x32_bf16 v[72:75], v[140:143], v[100:103], 0
    v_mfma_f32_16x16x32_bf16 v[76:79], v[144:147], v[100:103], 0
    v_mfma_f32_16x16x32_bf16 v[80:83], v[148:151], v[100:103], 0
    v_mfma_f32_16x16x32_bf16 v[84:87], v[152:155], v[100:103], 0
    buffer_load_dwordx4 v[100:103], v1, s[40:43], s71 offen offset:3072 sc1
    buffer_load_dwordx4 v[136:139], v1, s[40:43], s66 offen offset:0 sc1
    buffer_load_dwordx4 v[140:143], v1, s[40:43], s66 offen offset:1024 sc1
    buffer_load_dwordx4 v[144:147], v1, s[40:43], s66 offen offset:2048 sc1
    buffer_load_dwordx4 v[148:151], v1, s[40:43], s66 offen offset:3072 sc1
    buffer_load_dwordx4 v[152:155], v7, s[40:43], s66 offen sc1
    s_add_u32 s66, s66, 4608
    s_waitcnt vmcnt(16)
    v_mfma_f32_16x16x32_bf16 v[8:11], v[156:159], v[104:107], v[8:11]
    v_mfma_f32_16x16x32_bf16 v[12:15], v[160:163], v[104:107], v[12:15]
    v_mfma_f32_16x16x32_bf16 v[16:19], v[164:167], v[104:107], v[16:19]
    v_mfma_f32_16x16x32_bf16 v[20:23], v[168:171], v[104:107], v[20:23]
    v_mfma_f32_16x16x32_bf16 v[24:27], v[172:175], v[104:107], v[24:27]
    s_add_u32 s68, s68, 4096
    buffer_load_dwordx4 v[104:107], v1, s[40:43], s68 offen offset:0 sc1
    s_waitcnt vmcnt(16)
    v_mfma_f32_16x16x32_bf16 v[28:31], v[156:159], v[108:111], v[28:31]
    v_mfma_f32_16x16x32_bf16 v[32:35], v[160:163], v[108:111], v[32:35]
    v_mfma_f32_16x16x32_bf16 v[36:39], v[164:167], v[108:111], v[36:39]
    v_mfma_f32_16x16x32_bf16 v[40:43], v[168:171], v[108:111], v[40:43]
    v_mfma_f32_16x16x32_bf16 v[44:47], v[172:175], v[108:111], v[44:47]
    s_add_u32 s69, s69, 4096
    buffer_load_dwordx4 v[108:111], v1, s[40:43], s69 offen offset:0 sc1
    s_waitcnt vmcnt(16)
    v_mfma_f32_16x16x32_bf16 v[48:51], v[156:159], v[112:115], v[48:51]
    v_mfma_f32_16x16x32_bf16 v[52:55], v[160:163], v[112:115], v[52:55]
    v_mfma_f32_16x16x32_bf16 v[56:59], v[164:167], v[112:115], v[56:59]
    v_mfma_f32_16x16x32_bf16 v[60:63], v[168:171], v[112:115], v[60:63]
    v_mfma_f32_16x16x32_bf16 v[64:67], v[172:175], v[112:115], v[64:67]
    s_add_u32 s70, s70, 4096
    buffer_load_dwordx4 v[112:115], v1, s[40:43], s70 offen offset:0 sc1
    s_waitcnt vmcnt(16)
    v_mfma_f32_16x16x32_bf16 v[68:71], v[156:159], v[116:119], v[68:71]
    v_mfma_f32_16x16x32_bf16 v[72:75], v[160:163], v[116:119], v[72:75]
    v_mfma_f32_16x16x32_bf16 v[76:79], v[164:167], v[116:119], v[76:79]
    v_mfma_f32_16x16x32_bf16 v[80:83], v[168:171], v[116:119], v[80:83]
    v_mfma_f32_16x16x32_bf16 v[84:87], v[172:175], v[116:119], v[84:87]
    s_add_u32 s71, s71, 4096
    buffer_load_dwordx4 v[116:119], v1, s[40:43], s71 offen offset:0 sc1
    buffer_load_dwordx4 v[156:159], v1, s[40:43], s66 offen offset:0 sc1
    buffer_load_dwordx4 v[160:163], v1, s[40:43], s66 offen offset:1024 sc1
    buffer_load_dwordx4 v[164:167], v1, s[40:43], s66 offen offset:2048 sc1
    buffer_load_dwordx4 v[168:171], v1, s[40:43], s66 offen offset:3072 sc1
    buffer_load_dwordx4 v[172:175], v7, s[40:43], s66 offen sc1
    s_add_u32 s66, s66, 4608
    s_waitcnt vmcnt(21)
    v_mfma_f32_16x16x32_bf16 v[8:11], v[176:179], v[120:123], v[8:11]
    v_mfma_f32_16x16x32_bf16 v[12:15], v[180:183], v[120:123], v[12:15]
    v_mfma_f32_16x16x32_bf16 v[16:19], v[184:187], v[120:123], v[16:19]
    v_mfma_f32_16x16x32_bf16 v[20:23], v[188:191], v[120:123], v[20:23]
    v_mfma_f32_16x16x32_bf16 v[24:27], v[192:195], v[120:123], v[24:27]
    buffer_load_dwordx4 v[120:123], v1, s[40:43], s68 offen offset:1024 sc1
    s_waitcnt vmcnt(21)
    v_mfma_f32_16x16x32_bf16 v[28:31], v[176:179], v[124:127], v[28:31]
    v_mfma_f32_16x16x32_bf16 v[32:35], v[180:183], v[124:127], v[32:35]
    v_mfma_f32_16x16x32_bf16 v[36:39], v[184:187], v[124:127], v[36:39]
    v_mfma_f32_16x16x32_bf16 v[40:43], v[188:191], v[124:127], v[40:43]
    v_mfma_f32_16x16x32_bf16 v[44:47], v[192:195], v[124:127], v[44:47]
    buffer_load_dwordx4 v[124:127], v1, s[40:43], s69 offen offset:1024 sc1
    s_waitcnt vmcnt(21)
    v_mfma_f32_16x16x32_bf16 v[48:51], v[176:179], v[128:131], v[48:51]
    v_mfma_f32_16x16x32_bf16 v[52:55], v[180:183], v[128:131], v[52:55]
    v_mfma_f32_16x16x32_bf16 v[56:59], v[184:187], v[128:131], v[56:59]
    v_mfma_f32_16x16x32_bf16 v[60:63], v[188:191], v[128:131], v[60:63]
    v_mfma_f32_16x16x32_bf16 v[64:67], v[192:195], v[128:131], v[64:67]
    buffer_load_dwordx4 v[128:131], v1, s[40:43], s70 offen offset:1024 sc1
    s_waitcnt vmcnt(21)
    v_mfma_f32_16x16x32_bf16 v[68:71], v[176:179], v[132:135], v[68:71]
    v_mfma_f32_16x16x32_bf16 v[72:75], v[180:183], v[132:135], v[72:75]
    v_mfma_f32_16x16x32_bf16 v[76:79], v[184:187], v[132:135], v[76:79]
    v_mfma_f32_16x16x32_bf16 v[80:83], v[188:191], v[132:135], v[80:83]
    v_mfma_f32_16x16x32_bf16 v[84:87], v[192:195], v[132:135], v[84:87]
    buffer_load_dwordx4 v[132:135], v1, s[40:43], s71 offen offset:1024 sc1
    buffer_load_dwordx4 v[176:179], v1, s[40:43], s66 offen offset:0 sc1
    buffer_load_dwordx4 v[180:183], v1, s[40:43], s66 offen offset:1024 sc1
    buffer_load_dwordx4 v[184:187], v1, s[40:43], s66 offen offset:2048 sc1
    buffer_load_dwordx4 v[188:191], v1, s[40:43], s66 offen offset:3072 sc1
    buffer_load_dwordx4 v[192:195], v7, s[40:43], s66 offen sc1
    s_add_u32 s66, s66, 4608
    s_waitcnt vmcnt(26)
    v_mfma_f32_16x16x32_bf16 v[8:11], v[196:199], v[88:91], v[8:11]
    v_mfma_f32_16x16x32_bf16 v[12:15], v[200:203], v[88:91], v[12:15]
    v_mfma_f32_16x16x32_bf16 v[16:19], v[204:207], v[88:91], v[16:19]
    v_mfma_f32_16x16x32_bf16 v[20:23], v[208:211], v[88:91], v[20:23]
    v_mfma_f32_16x16x32_bf16 v[24:27], v[212:215], v[88:91], v[24:27]
    buffer_load_dwordx4 v[88:91], v1, s[40:43], s68 offen offset:2048 sc1
    s_waitcnt vmcnt(26)
    v_mfma_f32_16x16x32_bf16 v[28:31], v[196:199], v[92:95], v[28:31]
    v_mfma_f32_16x16x32_bf16 v[32:35], v[200:203], v[92:95], v[32:35]
    v_mfma_f32_16x16x32_bf16 v[36:39], v[204:207], v[92:95], v[36:39]
    v_mfma_f32_16x16x32_bf16 v[40:43], v[208:211], v[92:95], v[40:43]
    v_mfma_f32_16x16x32_bf16 v[44:47], v[212:215], v[92:95], v[44:47]
    buffer_load_dwordx4 v[92:95], v1, s[40:43], s69 offen offset:2048 sc1
    s_waitcnt vmcnt(26)
    v_mfma_f32_16x16x32_bf16 v[48:51], v[196:199], v[96:99], v[48:51]
    v_mfma_f32_16x16x32_bf16 v[52:55], v[200:203], v[96:99], v[52:55]
    v_mfma_f32_16x16x32_bf16 v[56:59], v[204:207], v[96:99], v[56:59]
    v_mfma_f32_16x16x32_bf16 v[60:63], v[208:211], v[96:99], v[60:63]
    v_mfma_f32_16x16x32_bf16 v[64:67], v[212:215], v[96:99], v[64:67]
    buffer_load_dwordx4 v[96:99], v1, s[40:43], s70 offen offset:2048 sc1
    s_waitcnt vmcnt(26)
    v_mfma_f32_16x16x32_bf16 v[68:71], v[196:199], v[100:103], v[68:71]
    v_mfma_f32_16x16x32_bf16 v[72:75], v[200:203], v[100:103], v[72:75]
    v_mfma_f32_16x16x32_bf16 v[76:79], v[204:207], v[100:103], v[76:79]
    v_mfma_f32_16x16x32_bf16 v[80:83], v[208:211], v[100:103], v[80:83]
    v_mfma_f32_16x16x32_bf16 v[84:87], v[212:215], v[100:103], v[84:87]
    buffer_load_dwordx4 v[100:103], v1, s[40:43], s71 offen offset:2048 sc1
    s_waitcnt vmcnt(21)
    v_mfma_f32_16x16x32_bf16 v[8:11], v[216:219], v[104:107], v[8:11]
    v_mul_u32_u24 v196, 3641, v0
    v_lshrrev_b32 v196, 16, v196
    v_mfma_f32_16x16x32_bf16 v[12:15], v[220:223], v[104:107], v[12:15]
    v_mul_u32_u24 v197, 18, v196
    v_sub_u32 v197, v0, v197
    v_mfma_f32_16x16x32_bf16 v[16:19], v[224:227], v[104:107], v[16:19]
    s_lshl_b32 s61, s44, 2
    s_add_u32 s61, s61, s4
    v_mfma_f32_16x16x32_bf16 v[20:23], v[228:231], v[104:107], v[20:23]
    s_mul_i32 s62, s61, 18432
    s_mul_i32 s63, s45, 144
    v_mfma_f32_16x16x32_bf16 v[24:27], v[232:235], v[104:107], v[24:27]
    s_add_u32 s62, s62, s63
    v_min_u32 v198, 2, v196
    buffer_load_dwordx4 v[104:107], v1, s[40:43], s68 offen offset:3072 sc1
    s_waitcnt vmcnt(21)
    v_mfma_f32_16x16x32_bf16 v[28:31], v[216:219], v[108:111], v[28:31]
    v_mul_u32_u24 v198, 1152, v198
    v_lshl_add_u32 v198, v197, 3, v198
    v_mfma_f32_16x16x32_bf16 v[32:35], v[220:223], v[108:111], v[32:35]
    v_lshl_add_u32 v199, v197, 3, s63
    s_lshl_b32 s57, s62, 1
    v_mfma_f32_16x16x32_bf16 v[36:39], v[224:227], v[108:111], v[36:39]
    s_lshl_b32 s61, s61, 6
    s_add_u32 s61, s61, 12115968
    v_mfma_f32_16x16x32_bf16 v[40:43], v[228:231], v[108:111], v[40:43]
    v_lshlrev_b32 v215, 2, v4
    buffer_load_dword v214, v215, s[40:43], s61 offen sc1
    v_mfma_f32_16x16x32_bf16 v[44:47], v[232:235], v[108:111], v[44:47]
    global_load_dwordx2 v[212:213], v199, s[24:25]
    buffer_load_dwordx2 v[200:201], v198, s[8:11], s62 offen
    buffer_load_dwordx4 v[108:111], v1, s[40:43], s69 offen offset:3072 sc1
    s_waitcnt vmcnt(24)
    v_mfma_f32_16x16x32_bf16 v[48:51], v[216:219], v[112:115], v[48:51]
    s_add_u32 s62, s62, 3456
    buffer_load_dwordx2 v[202:203], v198, s[8:11], s62 offen
    v_mfma_f32_16x16x32_bf16 v[52:55], v[220:223], v[112:115], v[52:55]
    s_add_u32 s62, s62, 3456
    buffer_load_dwordx2 v[204:205], v198, s[8:11], s62 offen
    v_mfma_f32_16x16x32_bf16 v[56:59], v[224:227], v[112:115], v[56:59]
    s_add_u32 s62, s62, 3456
    buffer_load_dwordx2 v[206:207], v198, s[8:11], s62 offen
    v_mfma_f32_16x16x32_bf16 v[60:63], v[228:231], v[112:115], v[60:63]
    s_add_u32 s62, s62, 3456
    buffer_load_dwordx2 v[208:209], v198, s[8:11], s62 offen
    v_mfma_f32_16x16x32_bf16 v[64:67], v[232:235], v[112:115], v[64:67]
    s_add_u32 s62, s62, 3456
    s_mov_b64 exec, 0x3ffff
    buffer_load_dwordx2 v[210:211], v198, s[8:11], s62 offen
    s_mov_b64 exec, -1
    buffer_load_dwordx4 v[112:115], v1, s[40:43], s70 offen offset:3072 sc1
    s_waitcnt vmcnt(29)
    v_mfma_f32_16x16x32_bf16 v[68:71], v[216:219], v[116:119], v[68:71]
    v_mfma_f32_16x16x32_bf16 v[72:75], v[220:223], v[116:119], v[72:75]
    v_mfma_f32_16x16x32_bf16 v[76:79], v[224:227], v[116:119], v[76:79]
    v_mfma_f32_16x16x32_bf16 v[80:83], v[228:231], v[116:119], v[80:83]
    v_mfma_f32_16x16x32_bf16 v[84:87], v[232:235], v[116:119], v[84:87]
    buffer_load_dwordx4 v[116:119], v1, s[40:43], s71 offen offset:3072 sc1
    s_waitcnt vmcnt(24)
    v_mfma_f32_16x16x32_bf16 v[8:11], v[236:239], v[120:123], v[8:11]
    v_mfma_f32_16x16x32_bf16 v[12:15], v[240:243], v[120:123], v[12:15]
    v_mfma_f32_16x16x32_bf16 v[16:19], v[244:247], v[120:123], v[16:19]
    v_mfma_f32_16x16x32_bf16 v[20:23], v[248:251], v[120:123], v[20:23]
    v_mfma_f32_16x16x32_bf16 v[24:27], v[252:255], v[120:123], v[24:27]
    s_add_u32 s68, s68, 4096
    buffer_load_dwordx4 v[120:123], v1, s[40:43], s68 offen offset:0 sc1
    s_waitcnt vmcnt(24)
    v_mfma_f32_16x16x32_bf16 v[28:31], v[236:239], v[124:127], v[28:31]
    v_mfma_f32_16x16x32_bf16 v[32:35], v[240:243], v[124:127], v[32:35]
    v_mfma_f32_16x16x32_bf16 v[36:39], v[244:247], v[124:127], v[36:39]
    v_mfma_f32_16x16x32_bf16 v[40:43], v[248:251], v[124:127], v[40:43]
    v_mfma_f32_16x16x32_bf16 v[44:47], v[252:255], v[124:127], v[44:47]
    s_add_u32 s69, s69, 4096
    buffer_load_dwordx4 v[124:127], v1, s[40:43], s69 offen offset:0 sc1
    s_waitcnt vmcnt(24)
    v_mfma_f32_16x16x32_bf16 v[48:51], v[236:239], v[128:131], v[48:51]
    v_mfma_f32_16x16x32_bf16 v[52:55], v[240:243], v[128:131], v[52:55]
    v_mfma_f32_16x16x32_bf16 v[56:59], v[244:247], v[128:131], v[56:59]
    v_mfma_f32_16x16x32_bf16 v[60:63], v[248:251], v[128:131], v[60:63]
    v_mfma_f32_16x16x32_bf16 v[64:67], v[252:255], v[128:131], v[64:67]
    s_add_u32 s70, s70, 4096
    buffer_load_dwordx4 v[128:131], v1, s[40:43], s70 offen offset:0 sc1
    s_waitcnt vmcnt(24)
    v_mfma_f32_16x16x32_bf16 v[68:71], v[236:239], v[132:135], v[68:71]
    v_mfma_f32_16x16x32_bf16 v[72:75], v[240:243], v[132:135], v[72:75]
    v_mfma_f32_16x16x32_bf16 v[76:79], v[244:247], v[132:135], v[76:79]
    v_mfma_f32_16x16x32_bf16 v[80:83], v[248:251], v[132:135], v[80:83]
    v_mfma_f32_16x16x32_bf16 v[84:87], v[252:255], v[132:135], v[84:87]
    s_add_u32 s71, s71, 4096
    buffer_load_dwordx4 v[132:135], v1, s[40:43], s71 offen offset:0 sc1
    s_waitcnt vmcnt(19)
    v_mfma_f32_16x16x32_bf16 v[8:11], v[136:139], v[88:91], v[8:11]
    v_mfma_f32_16x16x32_bf16 v[12:15], v[140:143], v[88:91], v[12:15]
    v_mfma_f32_16x16x32_bf16 v[16:19], v[144:147], v[88:91], v[16:19]
    v_mfma_f32_16x16x32_bf16 v[20:23], v[148:151], v[88:91], v[20:23]
    v_mfma_f32_16x16x32_bf16 v[24:27], v[152:155], v[88:91], v[24:27]
    s_waitcnt vmcnt(18)
    v_mfma_f32_16x16x32_bf16 v[28:31], v[136:139], v[92:95], v[28:31]
    v_mfma_f32_16x16x32_bf16 v[32:35], v[140:143], v[92:95], v[32:35]
    v_mfma_f32_16x16x32_bf16 v[36:39], v[144:147], v[92:95], v[36:39]
    v_mfma_f32_16x16x32_bf16 v[40:43], v[148:151], v[92:95], v[40:43]
    v_mfma_f32_16x16x32_bf16 v[44:47], v[152:155], v[92:95], v[44:47]
    s_waitcnt vmcnt(17)
    v_mfma_f32_16x16x32_bf16 v[48:51], v[136:139], v[96:99], v[48:51]
    v_mfma_f32_16x16x32_bf16 v[52:55], v[140:143], v[96:99], v[52:55]
    v_mfma_f32_16x16x32_bf16 v[56:59], v[144:147], v[96:99], v[56:59]
    v_mfma_f32_16x16x32_bf16 v[60:63], v[148:151], v[96:99], v[60:63]
    v_mfma_f32_16x16x32_bf16 v[64:67], v[152:155], v[96:99], v[64:67]
    s_waitcnt vmcnt(16)
    v_mfma_f32_16x16x32_bf16 v[68:71], v[136:139], v[100:103], v[68:71]
    v_mfma_f32_16x16x32_bf16 v[72:75], v[140:143], v[100:103], v[72:75]
    v_mfma_f32_16x16x32_bf16 v[76:79], v[144:147], v[100:103], v[76:79]
    v_mfma_f32_16x16x32_bf16 v[80:83], v[148:151], v[100:103], v[80:83]
    v_mfma_f32_16x16x32_bf16 v[84:87], v[152:155], v[100:103], v[84:87]
    s_waitcnt vmcnt(15)
    v_mfma_f32_16x16x32_bf16 v[8:11], v[156:159], v[104:107], v[8:11]
    v_mfma_f32_16x16x32_bf16 v[12:15], v[160:163], v[104:107], v[12:15]
    v_mfma_f32_16x16x32_bf16 v[16:19], v[164:167], v[104:107], v[16:19]
    v_mfma_f32_16x16x32_bf16 v[20:23], v[168:171], v[104:107], v[20:23]
    v_mfma_f32_16x16x32_bf16 v[24:27], v[172:175], v[104:107], v[24:27]
    s_waitcnt vmcnt(11)
    v_mfma_f32_16x16x32_bf16 v[28:31], v[156:159], v[108:111], v[28:31]
    v_mfma_f32_16x16x32_bf16 v[32:35], v[160:163], v[108:111], v[32:35]
    v_mfma_f32_16x16x32_bf16 v[36:39], v[164:167], v[108:111], v[36:39]
    v_mfma_f32_16x16x32_bf16 v[40:43], v[168:171], v[108:111], v[40:43]
    v_mfma_f32_16x16x32_bf16 v[44:47], v[172:175], v[108:111], v[44:47]
    s_waitcnt vmcnt(5)
    v_mfma_f32_16x16x32_bf16 v[48:51], v[156:159], v[112:115], v[48:51]
    v_mfma_f32_16x16x32_bf16 v[52:55], v[160:163], v[112:115], v[52:55]
    v_mfma_f32_16x16x32_bf16 v[56:59], v[164:167], v[112:115], v[56:59]
    v_mfma_f32_16x16x32_bf16 v[60:63], v[168:171], v[112:115], v[60:63]
    v_mfma_f32_16x16x32_bf16 v[64:67], v[172:175], v[112:115], v[64:67]
    s_waitcnt vmcnt(4)
    v_mfma_f32_16x16x32_bf16 v[68:71], v[156:159], v[116:119], v[68:71]
    v_mfma_f32_16x16x32_bf16 v[72:75], v[160:163], v[116:119], v[72:75]
    v_mfma_f32_16x16x32_bf16 v[76:79], v[164:167], v[116:119], v[76:79]
    v_mfma_f32_16x16x32_bf16 v[80:83], v[168:171], v[116:119], v[80:83]
    v_mfma_f32_16x16x32_bf16 v[84:87], v[172:175], v[116:119], v[84:87]
    s_waitcnt vmcnt(3)
    v_mfma_f32_16x16x32_bf16 v[8:11], v[176:179], v[120:123], v[8:11]
    v_cvt_pk_bf16_f32 v214, v214, v214
    v_lshlrev_b32 v214, 16, v214
    v_mfma_f32_16x16x32_bf16 v[12:15], v[180:183], v[120:123], v[12:15]
    v_mul_f32 v214, 3216550459, v214
    v_exp_f32 v214, v214
    v_mfma_f32_16x16x32_bf16 v[16:19], v[184:187], v[120:123], v[16:19]
    s_lshl_b32 s63, s4, 6
    s_add_u32 s63, s63, 163456
    v_mfma_f32_16x16x32_bf16 v[20:23], v[188:191], v[120:123], v[20:23]
    v_add_f32 v214, 1.0, v214
    v_rcp_f32 v214, v214
    v_mfma_f32_16x16x32_bf16 v[24:27], v[192:195], v[120:123], v[24:27]
    v_lshl_add_u32 v198, v4, 2, s63
    v_lshl_add_u32 v199, v196, 2, s63
    s_waitcnt vmcnt(2)
    v_mfma_f32_16x16x32_bf16 v[28:31], v[176:179], v[124:127], v[28:31]
    v_cvt_pk_bf16_f32 v214, v214, v214
    v_lshlrev_b32 v214, 16, v214
    v_mfma_f32_16x16x32_bf16 v[32:35], v[180:183], v[124:127], v[32:35]
    v_sub_f32 v215, 1.0, v214
    v_cvt_pk_bf16_f32 v214, v214, v215
    v_mfma_f32_16x16x32_bf16 v[36:39], v[184:187], v[124:127], v[36:39]
    ds_write_b32 v198, v214
    ds_read_b32 v217, v199 offset:0
    v_mfma_f32_16x16x32_bf16 v[40:43], v[188:191], v[124:127], v[40:43]
    ds_read_b32 v219, v199 offset:12
    ds_read_b32 v221, v199 offset:24
    v_mfma_f32_16x16x32_bf16 v[44:47], v[192:195], v[124:127], v[44:47]
    ds_read_b32 v223, v199 offset:36
    ds_read_b32 v225, v199 offset:48
    s_waitcnt vmcnt(1)
    v_mfma_f32_16x16x32_bf16 v[48:51], v[176:179], v[128:131], v[48:51]
    ds_read_b32 v227, v199 offset:60
    v_lshlrev_b32 v228, 16, v212
    v_mfma_f32_16x16x32_bf16 v[52:55], v[180:183], v[128:131], v[52:55]
    v_and_b32 v229, 0xffff0000, v212
    v_lshlrev_b32 v230, 16, v213
    v_mfma_f32_16x16x32_bf16 v[56:59], v[184:187], v[128:131], v[56:59]
    v_and_b32 v231, 0xffff0000, v213
    v_mul_u32_u24 v232, 288, v4
    v_mfma_f32_16x16x32_bf16 v[60:63], v[188:191], v[128:131], v[60:63]
    v_lshl_add_u32 v232, v5, 4, v232
    v_add_u32 v232, s67, v232
    v_mfma_f32_16x16x32_bf16 v[64:67], v[192:195], v[128:131], v[64:67]
    s_mul_i32 s62, s4, 4608
    v_add_u32 v234, s62, v1
    s_waitcnt vmcnt(0)
    v_mfma_f32_16x16x32_bf16 v[68:71], v[176:179], v[132:135], v[68:71]
    v_add_u32 v233, 82944, v234
    s_lshl_b32 s61, s4, 2
    v_mfma_f32_16x16x32_bf16 v[72:75], v[180:183], v[132:135], v[72:75]
    v_add_u32 v235, s61, v2
    v_mul_u32_u24 v196, 2304, v196
    v_mfma_f32_16x16x32_bf16 v[76:79], v[184:187], v[132:135], v[76:79]
    v_lshl_add_u32 v196, v197, 4, v196
    ds_read_b128 v[236:239], v2 offset:0
    v_mfma_f32_16x16x32_bf16 v[80:83], v[188:191], v[132:135], v[80:83]
    ds_read_b128 v[240:243], v2 offset:16
    v_mfma_f32_16x16x32_bf16 v[84:87], v[192:195], v[132:135], v[84:87]
    s_waitcnt lgkmcnt(1)
    v_min_u32 v236, v236, v237
    v_min3_u32 v236, v236, v238, v239
    v_cmp_gt_u32 vcc, 8, v236
    s_cbranch_vccz Lk_64
    s_mov_b32 s59, 0
    s_branch Le_67
Lw_65:
    s_sleep 2
Le_67:
    ds_read_b128 v[236:239], v2 offset:0
    s_add_u32 s59, s59, 1
    s_waitcnt lgkmcnt(0)
    v_min_u32 v236, v236, v237
    v_min3_u32 v236, v236, v238, v239
    v_cmp_gt_u32 vcc, 8, v236
    s_cmp_gt_u32 s59, 1000000
    s_cbranch_scc1 Lx_66
    s_cbranch_vccnz Lw_65
Lx_66:
Lk_64:
    s_waitcnt lgkmcnt(0)
    v_min_u32 v240, v240, v241
    v_min3_u32 v240, v240, v242, v243
    v_cmp_gt_u32 vcc, 4, v240
    s_cbranch_vccz Lk_68
    s_mov_b32 s59, 0
    s_branch Le_71
Lw_69:
    s_sleep 1
Le_71:
    ds_read_b128 v[240:243], v2 offset:16
    s_add_u32 s59, s59, 1
    s_waitcnt lgkmcnt(0)
    v_min_u32 v240, v240, v241
    v_min3_u32 v240, v240, v242, v243
    v_cmp_gt_u32 vcc, 4, v240
    s_cmp_gt_u32 s59, 1000000
    s_cbranch_scc1 Lx_70
    s_cbranch_vccnz Lw_69
Lx_70:
Lk_68:
    ds_write_b128 v232, v[8:11] offset:0
    ds_write_b128 v232, v[12:15] offset:64
    ds_write_b128 v232, v[16:19] offset:128
    ds_write_b128 v232, v[20:23] offset:192
    ds_write_b128 v232, v[28:31] offset:4608
    ds_write_b128 v232, v[32:35] offset:4672
    ds_write_b128 v232, v[36:39] offset:4736
    ds_write_b128 v232, v[40:43] offset:4800
    ds_write_b128 v232, v[48:51] offset:9216
    ds_write_b128 v232, v[52:55] offset:9280
    ds_write_b128 v232, v[56:59] offset:9344
    ds_write_b128 v232, v[60:63] offset:9408
    ds_write_b128 v232, v[68:71] offset:13824
    ds_write_b128 v232, v[72:75] offset:13888
    ds_write_b128 v232, v[76:79] offset:13952
    ds_write_b128 v232, v[80:83] offset:14016
    s_mov_b32 exec_hi, 0
    ds_write_b128 v232, v[24:27] offset:256
    ds_write_b128 v232, v[44:47] offset:4864
    ds_write_b128 v232, v[64:67] offset:9472
    ds_write_b128 v232, v[84:87] offset:14080
    s_mov_b64 exec, -1
    v_mov_b32 v6, 5
    ds_write_b32 v3, v6
    v_lshlrev_b32 v104, 16, v200
    v_and_b32 v105, 0xffff0000, v200
    v_lshlrev_b32 v106, 16, v201
    v_and_b32 v107, 0xffff0000, v201
    v_lshlrev_b32 v108, 16, v202
    v_and_b32 v109, 0xffff0000, v202
    v_lshlrev_b32 v110, 16, v203
    v_and_b32 v111, 0xffff0000, v203
    v_lshlrev_b32 v112, 16, v204
    v_and_b32 v113, 0xffff0000, v204
    v_lshlrev_b32 v114, 16, v205
    v_and_b32 v115, 0xffff0000, v205
    v_lshlrev_b32 v116, 16, v206
    v_and_b32 v117, 0xffff0000, v206
    v_lshlrev_b32 v118, 16, v207
    v_and_b32 v119, 0xffff0000, v207
    v_lshlrev_b32 v120, 16, v208
    v_and_b32 v121, 0xffff0000, v208
    v_lshlrev_b32 v122, 16, v209
    v_and_b32 v123, 0xffff0000, v209
    v_lshlrev_b32 v124, 16, v210
    v_and_b32 v125, 0xffff0000, v210
    v_lshlrev_b32 v126, 16, v211
    v_and_b32 v127, 0xffff0000, v211
    v_lshlrev_b32 v216, 16, v217
    v_and_b32 v217, 0xffff0000, v217
    v_lshlrev_b32 v218, 16, v219
    v_and_b32 v219, 0xffff0000, v219
    v_lshlrev_b32 v220, 16, v221
    v_and_b32 v221, 0xffff0000, v221
    v_lshlrev_b32 v222, 16, v223
    v_and_b32 v223, 0xffff0000, v223
    v_lshlrev_b32 v224, 16, v225
    v_and_b32 v225, 0xffff0000, v225
    v_lshlrev_b32 v226, 16, v227
    v_and_b32 v227, 0xffff0000, v227
    s_mov_b32 s59, 0
Lw_72:
    ds_read_b128 v[236:239], v2 offset:16
    s_add_u32 s59, s59, 1
    s_waitcnt lgkmcnt(0)
    v_min_u32 v236, v236, v237
    v_min3_u32 v236, v236, v238, v239
    v_cmp_gt_u32 vcc, 5, v236
    s_cmp_gt_u32 s59, 1000000
    s_cbranch_scc1 Lx_73
    s_cbranch_vccnz Lw_72
Lx_73:
    ds_read_b128 v[8:11], v233 offset:0
    ds_read_b128 v[12:15], v233 offset:18688
    ds_read_b128 v[16:19], v233 offset:37376
    ds_read_b128 v[20:23], v233 offset:56064
    ds_read_b128 v[24:27], v233 offset:864
    ds_read_b128 v[28:31], v233 offset:19552
    ds_read_b128 v[32:35], v233 offset:38240
    ds_read_b128 v[36:39], v233 offset:56928
    ds_read_b128 v[40:43], v233 offset:1728
    ds_read_b128 v[44:47], v233 offset:20416
    ds_read_b128 v[48:51], v233 offset:39104
    ds_read_b128 v[52:55], v233 offset:57792
    ds_read_b128 v[56:59], v233 offset:2592
    ds_read_b128 v[60:63], v233 offset:21280
    ds_read_b128 v[64:67], v233 offset:39968
    ds_read_b128 v[68:71], v233 offset:58656
    ds_read_b128 v[72:75], v233 offset:3456
    ds_read_b128 v[76:79], v233 offset:22144
    ds_read_b128 v[80:83], v233 offset:40832
    ds_read_b128 v[84:87], v233 offset:59520
    ds_read_b128 v[88:91], v233 offset:4320
    ds_read_b128 v[92:95], v233 offset:23008
    ds_read_b128 v[96:99], v233 offset:41696
    ds_read_b128 v[100:103], v233 offset:60384
    s_waitcnt lgkmcnt(15)
    v_fmac_f32 v8, v104, v228
    v_add_f32 v12, v12, v16
    v_fmac_f32 v9, v105, v229
    v_add_f32 v13, v13, v17
    v_fmac_f32 v10, v106, v230
    v_add_f32 v14, v14, v18
    v_fmac_f32 v11, v107, v231
    v_add_f32 v15, v15, v19
    v_add_f32 v8, v8, v20
    v_add_f32 v9, v9, v21
    v_add_f32 v10, v10, v22
    v_add_f32 v11, v11, v23
    v_add_f32 v8, v8, v12
    v_add_f32 v9, v9, v13
    v_add_f32 v10, v10, v14
    v_add_f32 v11, v11, v15
    v_mul_f32 v8, v8, v216
    v_mul_f32 v9, v9, v216
    v_mul_f32 v10, v10, v216
    v_mul_f32 v11, v11, v216
    s_waitcnt lgkmcnt(15)
    v_fmac_f32 v24, v108, v228
    v_add_f32 v28, v28, v32
    v_fmac_f32 v25, v109, v229
    v_add_f32 v29, v29, v33
    v_fmac_f32 v26, v110, v230
    v_add_f32 v30, v30, v34
    v_fmac_f32 v27, v111, v231
    v_add_f32 v31, v31, v35
    v_add_f32 v24, v24, v36
    v_add_f32 v25, v25, v37
    v_add_f32 v26, v26, v38
    v_add_f32 v27, v27, v39
    v_add_f32 v24, v24, v28
    v_add_f32 v25, v25, v29
    v_add_f32 v26, v26, v30
    v_add_f32 v27, v27, v31
    v_mul_f32 v24, v24, v218
    v_mul_f32 v25, v25, v218
    v_mul_f32 v26, v26, v218
    v_mul_f32 v27, v27, v218
    s_waitcnt lgkmcnt(12)
    v_fmac_f32 v40, v112, v228
    v_add_f32 v44, v44, v48
    v_fmac_f32 v41, v113, v229
    v_add_f32 v45, v45, v49
    v_fmac_f32 v42, v114, v230
    v_add_f32 v46, v46, v50
    v_fmac_f32 v43, v115, v231
    v_add_f32 v47, v47, v51
    v_add_f32 v40, v40, v52
    v_add_f32 v41, v41, v53
    v_add_f32 v42, v42, v54
    v_add_f32 v43, v43, v55
    v_add_f32 v40, v40, v44
    v_add_f32 v41, v41, v45
    v_add_f32 v42, v42, v46
    v_add_f32 v43, v43, v47
    v_mul_f32 v40, v40, v220
    v_mul_f32 v41, v41, v220
    v_mul_f32 v42, v42, v220
    v_mul_f32 v43, v43, v220
    s_waitcnt lgkmcnt(8)
    v_fmac_f32 v56, v116, v228
    v_add_f32 v60, v60, v64
    v_fmac_f32 v57, v117, v229
    v_add_f32 v61, v61, v65
    v_fmac_f32 v58, v118, v230
    v_add_f32 v62, v62, v66
    v_fmac_f32 v59, v119, v231
    v_add_f32 v63, v63, v67
    v_add_f32 v56, v56, v68
    v_add_f32 v57, v57, v69
    v_add_f32 v58, v58, v70
    v_add_f32 v59, v59, v71
    v_add_f32 v56, v56, v60
    v_add_f32 v57, v57, v61
    v_add_f32 v58, v58, v62
    v_add_f32 v59, v59, v63
    v_mul_f32 v56, v56, v222
    v_mul_f32 v57, v57, v222
    v_mul_f32 v58, v58, v222
    v_mul_f32 v59, v59, v222
    s_waitcnt lgkmcnt(4)
    v_fmac_f32 v72, v120, v228
    v_add_f32 v76, v76, v80
    v_fmac_f32 v73, v121, v229
    v_add_f32 v77, v77, v81
    v_fmac_f32 v74, v122, v230
    v_add_f32 v78, v78, v82
    v_fmac_f32 v75, v123, v231
    v_add_f32 v79, v79, v83
    v_add_f32 v72, v72, v84
    v_add_f32 v73, v73, v85
    v_add_f32 v74, v74, v86
    v_add_f32 v75, v75, v87
    v_add_f32 v72, v72, v76
    v_add_f32 v73, v73, v77
    v_add_f32 v74, v74, v78
    v_add_f32 v75, v75, v79
    v_mul_f32 v72, v72, v224
    v_mul_f32 v73, v73, v224
    v_mul_f32 v74, v74, v224
    v_mul_f32 v75, v75, v224
    s_waitcnt lgkmcnt(0)
    v_fmac_f32 v88, v124, v228
    v_add_f32 v92, v92, v96
    v_fmac_f32 v89, v125, v229
    v_add_f32 v93, v93, v97
    v_fmac_f32 v90, v126, v230
    v_add_f32 v94, v94, v98
    v_fmac_f32 v91, v127, v231
    v_add_f32 v95, v95, v99
    v_add_f32 v88, v88, v100
    v_add_f32 v89, v89, v101
    v_add_f32 v90, v90, v102
    v_add_f32 v91, v91, v103
    v_add_f32 v88, v88, v92
    v_add_f32 v89, v89, v93
    v_add_f32 v90, v90, v94
    v_add_f32 v91, v91, v95
    v_mul_f32 v88, v88, v226
    v_mul_f32 v89, v89, v226
    v_mul_f32 v90, v90, v226
    v_mul_f32 v91, v91, v226
    s_mov_b32 s59, 0
Lw_75:
    ds_read_b32 v236, v235
    s_add_u32 s59, s59, 1
    s_waitcnt lgkmcnt(0)
    v_cmp_gt_u32 vcc, 11, v236
    s_cmp_gt_u32 s59, 1000000
    s_cbranch_scc1 Lx_76
    s_cbranch_vccnz Lw_75
Lx_76:
    ds_read_b128 v[12:15], v234 offset:0
    ds_read_b128 v[28:31], v234 offset:864
    ds_read_b128 v[44:47], v234 offset:1728
    ds_read_b128 v[60:63], v234 offset:2592
    ds_read_b128 v[76:79], v234 offset:3456
    ds_read_b128 v[92:95], v234 offset:4320
    s_mov_b32 exec_hi, 0x3fffff
    s_waitcnt lgkmcnt(5)
    v_pk_fma_f32 v[8:9], v[12:13], v[216:217], v[8:9] op_sel:[0,1,0] op_sel_hi:[1,1,1]
    v_pk_fma_f32 v[10:11], v[14:15], v[216:217], v[10:11] op_sel:[0,1,0] op_sel_hi:[1,1,1]
    buffer_store_dwordx4 v[8:11], v196, s[36:39], s57 offen
    s_add_u32 s57, s57, 6912
    s_waitcnt lgkmcnt(4)
    v_pk_fma_f32 v[24:25], v[28:29], v[218:219], v[24:25] op_sel:[0,1,0] op_sel_hi:[1,1,1]
    v_pk_fma_f32 v[26:27], v[30:31], v[218:219], v[26:27] op_sel:[0,1,0] op_sel_hi:[1,1,1]
    buffer_store_dwordx4 v[24:27], v196, s[36:39], s57 offen
    s_add_u32 s57, s57, 6912
    s_waitcnt lgkmcnt(3)
    v_pk_fma_f32 v[40:41], v[44:45], v[220:221], v[40:41] op_sel:[0,1,0] op_sel_hi:[1,1,1]
    v_pk_fma_f32 v[42:43], v[46:47], v[220:221], v[42:43] op_sel:[0,1,0] op_sel_hi:[1,1,1]
    buffer_store_dwordx4 v[40:43], v196, s[36:39], s57 offen
    s_add_u32 s57, s57, 6912
    s_waitcnt lgkmcnt(2)
    v_pk_fma_f32 v[56:57], v[60:61], v[222:223], v[56:57] op_sel:[0,1,0] op_sel_hi:[1,1,1]
    v_pk_fma_f32 v[58:59], v[62:63], v[222:223], v[58:59] op_sel:[0,1,0] op_sel_hi:[1,1,1]
    buffer_store_dwordx4 v[56:59], v196, s[36:39], s57 offen
    s_add_u32 s57, s57, 6912
    s_waitcnt lgkmcnt(1)
    v_pk_fma_f32 v[72:73], v[76:77], v[224:225], v[72:73] op_sel:[0,1,0] op_sel_hi:[1,1,1]
    v_pk_fma_f32 v[74:75], v[78:79], v[224:225], v[74:75] op_sel:[0,1,0] op_sel_hi:[1,1,1]
    buffer_store_dwordx4 v[72:75], v196, s[36:39], s57 offen
    s_add_u32 s57, s57, 6912
    s_waitcnt lgkmcnt(0)
    v_pk_fma_f32 v[88:89], v[92:93], v[226:227], v[88:89] op_sel:[0,1,0] op_sel_hi:[1,1,1]
    v_pk_fma_f32 v[90:91], v[94:95], v[226:227], v[90:91] op_sel:[0,1,0] op_sel_hi:[1,1,1]
    s_mov_b64 exec, 0x3ffff
    buffer_store_dwordx4 v[88:91], v196, s[36:39], s57 offen
    s_add_u32 s57, s57, 6912
    s_mov_b64 exec, -1
    s_branch L_fin
L_A2:
    v_add_u32 v21, 51200, v1
    s_waitcnt vmcnt(8)
    v_mov_b32 v22, 1
    ds_write_b32 v19, v22
    s_mov_b32 s59, 0
Lw_1:
    ds_read_b128 v[24:27], v18 offset:0
    s_add_u32 s59, s59, 1
    s_waitcnt lgkmcnt(0)
    v_min_u32 v24, v24, v25
    v_min3_u32 v24, v24, v26, v27
    v_cmp_gt_u32 vcc, 1, v24
    s_cmp_gt_u32 s59, 1000000
    s_cbranch_scc1 Lx_2
    s_cbranch_vccnz Lw_1
Lx_2:
    ds_read_b128 v[32:35], v1 offset:0
    ds_read_b128 v[36:39], v1 offset:1024
    ds_read_b128 v[40:43], v1 offset:2048
    ds_read_b128 v[44:47], v1 offset:3072
    ds_read_b128 v[48:51], v1 offset:4096
    ds_read_b128 v[52:55], v1 offset:5120
    ds_read_b128 v[56:59], v1 offset:6144
    ds_read_b128 v[60:63], v1 offset:7168
    ds_read_b128 v[64:67], v1 offset:8192
    ds_read_b128 v[68:71], v1 offset:9216
    s_waitcnt lgkmcnt(5)
    v_mfma_f32_16x16x32_bf16 v[72:75], v[32:35], v[112:115], 0
    v_mfma_f32_16x16x32_bf16 v[76:79], v[32:35], v[116:119], 0
    ds_read_b128 v[32:35], v1 offset:10240
    v_mfma_f32_16x16x32_bf16 v[80:83], v[36:39], v[112:115], 0
    s_add_u32 m0, s56, 65536
    s_nop 0
    buffer_load_dwordx4 v1, s[40:43], s55 offen offset:0 sc1 lds
    v_mfma_f32_16x16x32_bf16 v[84:87], v[36:39], v[116:119], 0
    ds_read_b128 v[36:39], v1 offset:11264
    v_mfma_f32_16x16x32_bf16 v[96:99], v[40:43], v[112:115], 0
    v_mfma_f32_16x16x32_bf16 v[100:103], v[40:43], v[116:119], 0
    ds_read_b128 v[40:43], v1 offset:12288
    v_mfma_f32_16x16x32_bf16 v[104:107], v[44:47], v[112:115], 0
    buffer_load_dwordx4 v1, s[40:43], s55 offen offset:1024 sc1 lds
    v_mfma_f32_16x16x32_bf16 v[108:111], v[44:47], v[116:119], 0
    ds_read_b128 v[44:47], v1 offset:13312
    v_mfma_f32_16x16x32_bf16 v[88:91], v[48:51], v[112:115], 0
    v_mfma_f32_16x16x32_bf16 v[92:95], v[48:51], v[116:119], 0
    ds_read_b128 v[48:51], v1 offset:14336
    s_waitcnt lgkmcnt(5)
    v_mfma_f32_16x16x32_bf16 v[72:75], v[52:55], v[120:123], v[72:75]
    v_mfma_f32_16x16x32_bf16 v[76:79], v[52:55], v[124:127], v[76:79]
    ds_read_b128 v[52:55], v1 offset:15360
    v_mfma_f32_16x16x32_bf16 v[80:83], v[56:59], v[120:123], v[80:83]
    buffer_load_dwordx4 v1, s[40:43], s55 offen offset:2048 sc1 lds
    v_mfma_f32_16x16x32_bf16 v[84:87], v[56:59], v[124:127], v[84:87]
    ds_read_b128 v[56:59], v1 offset:16384
    v_mfma_f32_16x16x32_bf16 v[96:99], v[60:63], v[120:123], v[96:99]
    v_mfma_f32_16x16x32_bf16 v[100:103], v[60:63], v[124:127], v[100:103]
    ds_read_b128 v[60:63], v1 offset:17408
    v_mfma_f32_16x16x32_bf16 v[104:107], v[64:67], v[120:123], v[104:107]
    buffer_load_dwordx4 v1, s[40:43], s55 offen offset:3072 sc1 lds
    s_add_u32 s55, s55, 16384
    v_mfma_f32_16x16x32_bf16 v[108:111], v[64:67], v[124:127], v[108:111]
    ds_read_b128 v[64:67], v1 offset:18432
    v_mfma_f32_16x16x32_bf16 v[88:91], v[68:71], v[120:123], v[88:91]
    v_mfma_f32_16x16x32_bf16 v[92:95], v[68:71], v[124:127], v[92:95]
    ds_read_b128 v[68:71], v1 offset:19456
    s_waitcnt lgkmcnt(5)
    v_mfma_f32_16x16x32_bf16 v[72:75], v[32:35], v[128:131], v[72:75]
    v_mfma_f32_16x16x32_bf16 v[76:79], v[32:35], v[132:135], v[76:79]
    ds_read_b128 v[32:35], v1 offset:20480
    v_mfma_f32_16x16x32_bf16 v[80:83], v[36:39], v[128:131], v[80:83]
    s_add_u32 m0, s56, 81920
    s_nop 0
    buffer_load_dwordx4 v1, s[40:43], s55 offen offset:0 sc1 lds
    v_mfma_f32_16x16x32_bf16 v[84:87], v[36:39], v[132:135], v[84:87]
    ds_read_b128 v[36:39], v1 offset:21504
    v_mfma_f32_16x16x32_bf16 v[96:99], v[40:43], v[128:131], v[96:99]
    s_waitcnt vmcnt(5)
    v_mov_b32 v22, 2
    ds_write_b32 v19, v22
    v_mfma_f32_16x16x32_bf16 v[100:103], v[40:43], v[132:135], v[100:103]
    ds_read_b128 v[40:43], v1 offset:22528
    v_mfma_f32_16x16x32_bf16 v[104:107], v[44:47], v[128:131], v[104:107]
    buffer_load_dwordx4 v1, s[40:43], s55 offen offset:1024 sc1 lds
    v_mfma_f32_16x16x32_bf16 v[108:111], v[44:47], v[132:135], v[108:111]
    ds_read_b128 v[44:47], v1 offset:23552
    v_mfma_f32_16x16x32_bf16 v[88:91], v[48:51], v[128:131], v[88:91]
    v_mfma_f32_16x16x32_bf16 v[92:95], v[48:51], v[132:135], v[92:95]
    ds_read_b128 v[48:51], v1 offset:24576
    s_waitcnt lgkmcnt(5)
    v_mfma_f32_16x16x32_bf16 v[72:75], v[52:55], v[136:139], v[72:75]
    v_mfma_f32_16x16x32_bf16 v[76:79], v[52:55], v[140:143], v[76:79]
    ds_read_b128 v[52:55], v1 offset:25600
    ds_read_b128 v[24:27], v18 offset:0
    v_mfma_f32_16x16x32_bf16 v[80:83], v[56:59], v[136:139], v[80:83]
    buffer_load_dwordx4 v1, s[40:43], s55 offen offset:2048 sc1 lds
    v_mfma_f32_16x16x32_bf16 v[84:87], v[56:59], v[140:143], v[84:87]
    ds_read_b128 v[56:59], v1 offset:26624
    v_mfma_f32_16x16x32_bf16 v[96:99], v[60:63], v[136:139], v[96:99]
    v_mfma_f32_16x16x32_bf16 v[100:103], v[60:63], v[140:143], v[100:103]
    ds_read_b128 v[60:63], v1 offset:27648
    v_mfma_f32_16x16x32_bf16 v[104:107], v[64:67], v[136:139], v[104:107]
    buffer_load_dwordx4 v1, s[40:43], s55 offen offset:3072 sc1 lds
    s_add_u32 s55, s55, 16384
    v_mfma_f32_16x16x32_bf16 v[108:111], v[64:67], v[140:143], v[108:111]
    ds_read_b128 v[64:67], v1 offset:28672
    v_mfma_f32_16x16x32_bf16 v[88:91], v[68:71], v[136:139], v[88:91]
    v_mfma_f32_16x16x32_bf16 v[92:95], v[68:71], v[140:143], v[92:95]
    ds_read_b128 v[68:71], v1 offset:29696
    s_waitcnt lgkmcnt(4)
    v_min_u32 v24, v24, v25
    v_min3_u32 v24, v24, v26, v27
    v_cmp_gt_u32 vcc, 2, v24
    s_cbranch_vccz Lk_4
    s_mov_b32 s59, 0
Lw_5:
    ds_read_b128 v[24:27], v18 offset:0
    s_add_u32 s59, s59, 1
    s_waitcnt lgkmcnt(0)
    v_min_u32 v24, v24, v25
    v_min3_u32 v24, v24, v26, v27
    v_cmp_gt_u32 vcc, 2, v24
    s_cmp_gt_u32 s59, 1000000
    s_cbranch_scc1 Lx_6
    s_cbranch_vccnz Lw_5
Lx_6:
Lk_4:
    v_mfma_f32_16x16x32_bf16 v[72:75], v[32:35], v[144:147], v[72:75]
    v_mfma_f32_16x16x32_bf16 v[76:79], v[32:35], v[148:151], v[76:79]
    ds_read_b128 v[32:35], v1 offset:30720
    v_mfma_f32_16x16x32_bf16 v[80:83], v[36:39], v[144:147], v[80:83]
    v_mfma_f32_16x16x32_bf16 v[84:87], v[36:39], v[148:151], v[84:87]
    ds_read_b128 v[36:39], v1 offset:31744
    v_mfma_f32_16x16x32_bf16 v[96:99], v[40:43], v[144:147], v[96:99]
    v_mfma_f32_16x16x32_bf16 v[100:103], v[40:43], v[148:151], v[100:103]
    ds_read_b128 v[40:43], v1 offset:32768
    v_mfma_f32_16x16x32_bf16 v[104:107], v[44:47], v[144:147], v[104:107]
    v_mfma_f32_16x16x32_bf16 v[108:111], v[44:47], v[148:151], v[108:111]
    ds_read_b128 v[44:47], v1 offset:33792
    v_mfma_f32_16x16x32_bf16 v[88:91], v[48:51], v[144:147], v[88:91]
    v_mfma_f32_16x16x32_bf16 v[92:95], v[48:51], v[148:151], v[92:95]
    ds_read_b128 v[48:51], v1 offset:34816
    s_waitcnt lgkmcnt(5)
    v_mfma_f32_16x16x32_bf16 v[72:75], v[52:55], v[152:155], v[72:75]
    v_mfma_f32_16x16x32_bf16 v[76:79], v[52:55], v[156:159], v[76:79]
    ds_read_b128 v[52:55], v1 offset:35840
    v_mfma_f32_16x16x32_bf16 v[80:83], v[56:59], v[152:155], v[80:83]
    v_mfma_f32_16x16x32_bf16 v[84:87], v[56:59], v[156:159], v[84:87]
    ds_read_b128 v[56:59], v1 offset:36864
    v_mfma_f32_16x16x32_bf16 v[96:99], v[60:63], v[152:155], v[96:99]
    v_mfma_f32_16x16x32_bf16 v[100:103], v[60:63], v[156:159], v[100:103]
    ds_read_b128 v[60:63], v1 offset:37888
    v_mfma_f32_16x16x32_bf16 v[104:107], v[64:67], v[152:155], v[104:107]
    v_mfma_f32_16x16x32_bf16 v[108:111], v[64:67], v[156:159], v[108:111]
    ds_read_b128 v[64:67], v1 offset:38912
    v_mfma_f32_16x16x32_bf16 v[88:91], v[68:71], v[152:155], v[88:91]
    v_mfma_f32_16x16x32_bf16 v[92:95], v[68:71], v[156:159], v[92:95]
    ds_read_b128 v[68:71], v1 offset:39936
    s_waitcnt lgkmcnt(5)
    v_mfma_f32_16x16x32_bf16 v[72:75], v[32:35], v[160:163], v[72:75]
    v_mfma_f32_16x16x32_bf16 v[76:79], v[32:35], v[164:167], v[76:79]
    ds_read_b128 v[32:35], v1 offset:40960
    v_mfma_f32_16x16x32_bf16 v[80:83], v[36:39], v[160:163], v[80:83]
    v_mfma_f32_16x16x32_bf16 v[84:87], v[36:39], v[164:167], v[84:87]
    ds_read_b128 v[36:39], v1 offset:41984
    v_mfma_f32_16x16x32_bf16 v[96:99], v[40:43], v[160:163], v[96:99]
    v_mfma_f32_16x16x32_bf16 v[100:103], v[40:43], v[164:167], v[100:103]
    ds_read_b128 v[40:43], v1 offset:43008
    v_mfma_f32_16x16x32_bf16 v[104:107], v[44:47], v[160:163], v[104:107]
    v_mfma_f32_16x16x32_bf16 v[108:111], v[44:47], v[164:167], v[108:111]
    ds_read_b128 v[44:47], v1 offset:44032
    v_mfma_f32_16x16x32_bf16 v[88:91], v[48:51], v[160:163], v[88:91]
    v_mfma_f32_16x16x32_bf16 v[92:95], v[48:51], v[164:167], v[92:95]
    ds_read_b128 v[48:51], v1 offset:45056
    s_waitcnt lgkmcnt(5)
    v_mfma_f32_16x16x32_bf16 v[72:75], v[52:55], v[168:171], v[72:75]
    v_mfma_f32_16x16x32_bf16 v[76:79], v[52:55], v[172:175], v[76:79]
    ds_read_b128 v[52:55], v1 offset:46080
    v_mfma_f32_16x16x32_bf16 v[80:83], v[56:59], v[168:171], v[80:83]
    v_mfma_f32_16x16x32_bf16 v[84:87], v[56:59], v[172:175], v[84:87]
    ds_read_b128 v[56:59], v1 offset:47104
    v_mfma_f32_16x16x32_bf16 v[96:99], v[60:63], v[168:171], v[96:99]
    v_mfma_f32_16x16x32_bf16 v[100:103], v[60:63], v[172:175], v[100:103]
    ds_read_b128 v[60:63], v1 offset:48128
    v_mfma_f32_16x16x32_bf16 v[104:107], v[64:67], v[168:171], v[104:107]
    v_mfma_f32_16x16x32_bf16 v[108:111], v[64:67], v[172:175], v[108:111]
    ds_read_b128 v[64:67], v1 offset:49152
    v_mfma_f32_16x16x32_bf16 v[88:91], v[68:71], v[168:171], v[88:91]
    v_mfma_f32_16x16x32_bf16 v[92:95], v[68:71], v[172:175], v[92:95]
    ds_read_b128 v[68:71], v1 offset:50176
    s_waitcnt lgkmcnt(5)
    v_mfma_f32_16x16x32_bf16 v[72:75], v[32:35], v[176:179], v[72:75]
    v_mfma_f32_16x16x32_bf16 v[76:79], v[32:35], v[180:183], v[76:79]
    ds_read_b128 v[32:35], v21 offset:0
    v_mfma_f32_16x16x32_bf16 v[80:83], v[36:39], v[176:179], v[80:83]
    v_mfma_f32_16x16x32_bf16 v[84:87], v[36:39], v[180:183], v[84:87]
    ds_read_b128 v[36:39], v21 offset:1024
    v_mfma_f32_16x16x32_bf16 v[96:99], v[40:43], v[176:179], v[96:99]
    s_waitcnt vmcnt(0)
    v_mov_b32 v22, 3
    ds_write_b32 v19, v22
    v_mfma_f32_16x16x32_bf16 v[100:103], v[40:43], v[180:183], v[100:103]
    ds_read_b128 v[40:43], v21 offset:2048
    v_mfma_f32_16x16x32_bf16 v[104:107], v[44:47], v[176:179], v[104:107]
    v_mfma_f32_16x16x32_bf16 v[108:111], v[44:47], v[180:183], v[108:111]
    ds_read_b128 v[44:47], v21 offset:3072
    v_mfma_f32_16x16x32_bf16 v[88:91], v[48:51], v[176:179], v[88:91]
    v_mfma_f32_16x16x32_bf16 v[92:95], v[48:51], v[180:183], v[92:95]
    ds_read_b128 v[48:51], v21 offset:4096
    s_waitcnt lgkmcnt(5)
    v_mfma_f32_16x16x32_bf16 v[72:75], v[52:55], v[184:187], v[72:75]
    v_mfma_f32_16x16x32_bf16 v[76:79], v[52:55], v[188:191], v[76:79]
    ds_read_b128 v[52:55], v21 offset:5120
    ds_read_b128 v[24:27], v18 offset:0
    v_mfma_f32_16x16x32_bf16 v[80:83], v[56:59], v[184:187], v[80:83]
    v_mfma_f32_16x16x32_bf16 v[84:87], v[56:59], v[188:191], v[84:87]
    ds_read_b128 v[56:59], v21 offset:6144
    v_mfma_f32_16x16x32_bf16 v[96:99], v[60:63], v[184:187], v[96:99]
    v_mfma_f32_16x16x32_bf16 v[100:103], v[60:63], v[188:191], v[100:103]
    ds_read_b128 v[60:63], v21 offset:7168
    v_mfma_f32_16x16x32_bf16 v[104:107], v[64:67], v[184:187], v[104:107]
    v_mfma_f32_16x16x32_bf16 v[108:111], v[64:67], v[188:191], v[108:111]
    ds_read_b128 v[64:67], v21 offset:8192
    v_mfma_f32_16x16x32_bf16 v[88:91], v[68:71], v[184:187], v[88:91]
    v_mfma_f32_16x16x32_bf16 v[92:95], v[68:71], v[188:191], v[92:95]
    ds_read_b128 v[68:71], v21 offset:9216
    s_waitcnt lgkmcnt(4)
    v_min_u32 v24, v24, v25
    v_min3_u32 v24, v24, v26, v27
    v_cmp_gt_u32 vcc, 3, v24
    s_cbranch_vccz Lk_8
    s_mov_b32 s59, 0
Lw_9:
    ds_read_b128 v[24:27], v18 offset:0
    s_add_u32 s59, s59, 1
    s_waitcnt lgkmcnt(0)
    v_min_u32 v24, v24, v25
    v_min3_u32 v24, v24, v26, v27
    v_cmp_gt_u32 vcc, 3, v24
    s_cmp_gt_u32 s59, 1000000
    s_cbranch_scc1 Lx_10
    s_cbranch_vccnz Lw_9
Lx_10:
Lk_8:
    v_mfma_f32_16x16x32_bf16 v[72:75], v[32:35], v[192:195], v[72:75]
    v_mfma_f32_16x16x32_bf16 v[76:79], v[32:35], v[196:199], v[76:79]
    ds_read_b128 v[32:35], v21 offset:10240
    v_mfma_f32_16x16x32_bf16 v[80:83], v[36:39], v[192:195], v[80:83]
    v_mfma_f32_16x16x32_bf16 v[84:87], v[36:39], v[196:199], v[84:87]
    ds_read_b128 v[36:39], v21 offset:11264
    v_mfma_f32_16x16x32_bf16 v[96:99], v[40:43], v[192:195], v[96:99]
    v_mfma_f32_16x16x32_bf16 v[100:103], v[40:43], v[196:199], v[100:103]
    ds_read_b128 v[40:43], v21 offset:12288
    v_mfma_f32_16x16x32_bf16 v[104:107], v[44:47], v[192:195], v[104:107]
    v_mfma_f32_16x16x32_bf16 v[108:111], v[44:47], v[196:199], v[108:111]
    ds_read_b128 v[44:47], v21 offset:13312
    v_mfma_f32_16x16x32_bf16 v[88:91], v[48:51], v[192:195], v[88:91]
    v_mfma_f32_16x16x32_bf16 v[92:95], v[48:51], v[196:199], v[92:95]
    ds_read_b128 v[48:51], v21 offset:14336
    s_waitcnt lgkmcnt(5)
    v_mfma_f32_16x16x32_bf16 v[72:75], v[52:55], v[200:203], v[72:75]
    v_mfma_f32_16x16x32_bf16 v[76:79], v[52:55], v[204:207], v[76:79]
    ds_read_b128 v[52:55], v21 offset:15360
    v_mfma_f32_16x16x32_bf16 v[80:83], v[56:59], v[200:203], v[80:83]
    v_mfma_f32_16x16x32_bf16 v[84:87], v[56:59], v[204:207], v[84:87]
    ds_read_b128 v[56:59], v21 offset:16384
    v_mfma_f32_16x16x32_bf16 v[96:99], v[60:63], v[200:203], v[96:99]
    v_mfma_f32_16x16x32_bf16 v[100:103], v[60:63], v[204:207], v[100:103]
    ds_read_b128 v[60:63], v21 offset:17408
    v_mfma_f32_16x16x32_bf16 v[104:107], v[64:67], v[200:203], v[104:107]
    v_mfma_f32_16x16x32_bf16 v[108:111], v[64:67], v[204:207], v[108:111]
    ds_read_b128 v[64:67], v21 offset:18432
    v_mfma_f32_16x16x32_bf16 v[88:91], v[68:71], v[200:203], v[88:91]
    v_mfma_f32_16x16x32_bf16 v[92:95], v[68:71], v[204:207], v[92:95]
    ds_read_b128 v[68:71], v21 offset:19456
    s_waitcnt lgkmcnt(5)
    v_mfma_f32_16x16x32_bf16 v[72:75], v[32:35], v[208:211], v[72:75]
    v_mfma_f32_16x16x32_bf16 v[76:79], v[32:35], v[212:215], v[76:79]
    ds_read_b128 v[32:35], v21 offset:20480
    v_mfma_f32_16x16x32_bf16 v[80:83], v[36:39], v[208:211], v[80:83]
    v_mfma_f32_16x16x32_bf16 v[84:87], v[36:39], v[212:215], v[84:87]
    ds_read_b128 v[36:39], v21 offset:21504
    v_mfma_f32_16x16x32_bf16 v[96:99], v[40:43], v[208:211], v[96:99]
    v_mfma_f32_16x16x32_bf16 v[100:103], v[40:43], v[212:215], v[100:103]
    ds_read_b128 v[40:43], v21 offset:22528
    v_mfma_f32_16x16x32_bf16 v[104:107], v[44:47], v[208:211], v[104:107]
    v_mfma_f32_16x16x32_bf16 v[108:111], v[44:47], v[212:215], v[108:111]
    ds_read_b128 v[44:47], v21 offset:23552
    v_mfma_f32_16x16x32_bf16 v[88:91], v[48:51], v[208:211], v[88:91]
    v_mfma_f32_16x16x32_bf16 v[92:95], v[48:51], v[212:215], v[92:95]
    ds_read_b128 v[48:51], v21 offset:24576
    s_waitcnt lgkmcnt(5)
    v_mfma_f32_16x16x32_bf16 v[72:75], v[52:55], v[216:219], v[72:75]
    v_mfma_f32_16x16x32_bf16 v[76:79], v[52:55], v[220:223], v[76:79]
    ds_read_b128 v[52:55], v21 offset:25600
    v_mfma_f32_16x16x32_bf16 v[80:83], v[56:59], v[216:219], v[80:83]
    v_mfma_f32_16x16x32_bf16 v[84:87], v[56:59], v[220:223], v[84:87]
    ds_read_b128 v[56:59], v21 offset:26624
    v_mfma_f32_16x16x32_bf16 v[96:99], v[60:63], v[216:219], v[96:99]
    v_mfma_f32_16x16x32_bf16 v[100:103], v[60:63], v[220:223], v[100:103]
    ds_read_b128 v[60:63], v21 offset:27648
    v_mfma_f32_16x16x32_bf16 v[104:107], v[64:67], v[216:219], v[104:107]
    v_mfma_f32_16x16x32_bf16 v[108:111], v[64:67], v[220:223], v[108:111]
    ds_read_b128 v[64:67], v21 offset:28672
    v_mfma_f32_16x16x32_bf16 v[88:91], v[68:71], v[216:219], v[88:91]
    v_mfma_f32_16x16x32_bf16 v[92:95], v[68:71], v[220:223], v[92:95]
    ds_read_b128 v[68:71], v21 offset:29696
    s_waitcnt lgkmcnt(5)
    v_mfma_f32_16x16x32_bf16 v[72:75], v[32:35], v[224:227], v[72:75]
    v_mfma_f32_16x16x32_bf16 v[76:79], v[32:35], v[228:231], v[76:79]
    ds_read_b128 v[32:35], v21 offset:30720
    v_mfma_f32_16x16x32_bf16 v[80:83], v[36:39], v[224:227], v[80:83]
    v_mfma_f32_16x16x32_bf16 v[84:87], v[36:39], v[228:231], v[84:87]
    ds_read_b128 v[36:39], v21 offset:31744
    v_mfma_f32_16x16x32_bf16 v[96:99], v[40:43], v[224:227], v[96:99]
    v_mfma_f32_16x16x32_bf16 v[100:103], v[40:43], v[228:231], v[100:103]
    ds_read_b128 v[40:43], v21 offset:32768
    v_mfma_f32_16x16x32_bf16 v[104:107], v[44:47], v[224:227], v[104:107]
    v_mfma_f32_16x16x32_bf16 v[108:111], v[44:47], v[228:231], v[108:111]
    ds_read_b128 v[44:47], v21 offset:33792
    v_mfma_f32_16x16x32_bf16 v[88:91], v[48:51], v[224:227], v[88:91]
    v_mfma_f32_16x16x32_bf16 v[92:95], v[48:51], v[228:231], v[92:95]
    ds_read_b128 v[48:51], v21 offset:34816
    s_waitcnt lgkmcnt(5)
    v_mfma_f32_16x16x32_bf16 v[72:75], v[52:55], v[232:235], v[72:75]
    v_mfma_f32_16x16x32_bf16 v[76:79], v[52:55], v[236:239], v[76:79]
    ds_read_b128 v[52:55], v21 offset:35840
    v_mfma_f32_16x16x32_bf16 v[80:83], v[56:59], v[232:235], v[80:83]
    v_mfma_f32_16x16x32_bf16 v[84:87], v[56:59], v[236:239], v[84:87]
    ds_read_b128 v[56:59], v21 offset:36864
    v_mfma_f32_16x16x32_bf16 v[96:99], v[60:63], v[232:235], v[96:99]
    v_mfma_f32_16x16x32_bf16 v[100:103], v[60:63], v[236:239], v[100:103]
    ds_read_b128 v[60:63], v21 offset:37888
    v_mfma_f32_16x16x32_bf16 v[104:107], v[64:67], v[232:235], v[104:107]
    v_mfma_f32_16x16x32_bf16 v[108:111], v[64:67], v[236:239], v[108:111]
    ds_read_b128 v[64:67], v21 offset:38912
    v_mfma_f32_16x16x32_bf16 v[88:91], v[68:71], v[232:235], v[88:91]
    v_mfma_f32_16x16x32_bf16 v[92:95], v[68:71], v[236:239], v[92:95]
    ds_read_b128 v[68:71], v21 offset:39936
    s_waitcnt lgkmcnt(5)
    v_mfma_f32_16x16x32_bf16 v[72:75], v[32:35], v[240:243], v[72:75]
    v_mfma_f32_16x16x32_bf16 v[76:79], v[32:35], v[244:247], v[76:79]
    ds_read_b128 v[32:35], v20 offset:0
    v_mfma_f32_16x16x32_bf16 v[80:83], v[36:39], v[240:243], v[80:83]
    v_mfma_f32_16x16x32_bf16 v[84:87], v[36:39], v[244:247], v[84:87]
    ds_read_b128 v[36:39], v20 offset:1024
    v_mfma_f32_16x16x32_bf16 v[96:99], v[40:43], v[240:243], v[96:99]
    v_mfma_f32_16x16x32_bf16 v[100:103], v[40:43], v[244:247], v[100:103]
    ds_read_b128 v[40:43], v20 offset:2048
    v_mfma_f32_16x16x32_bf16 v[104:107], v[44:47], v[240:243], v[104:107]
    v_mfma_f32_16x16x32_bf16 v[108:111], v[44:47], v[244:247], v[108:111]
    ds_read_b64 v[44:45], v23 offset:0
    ds_read_b64 v[46:47], v23 offset:512
    v_mfma_f32_16x16x32_bf16 v[88:91], v[48:51], v[240:243], v[88:91]
    v_mfma_f32_16x16x32_bf16 v[92:95], v[48:51], v[244:247], v[92:95]
    ds_read_b64 v[48:49], v23 offset:1024
    s_waitcnt lgkmcnt(6)
    v_mfma_f32_16x16x32_bf16 v[72:75], v[52:55], v[248:251], v[72:75]
    v_mov_b32 v22, 4
    ds_write_b32 v19, v22
    v_mfma_f32_16x16x32_bf16 v[76:79], v[52:55], v[252:255], v[76:79]
    v_mfma_f32_16x16x32_bf16 v[80:83], v[56:59], v[248:251], v[80:83]
    v_mfma_f32_16x16x32_bf16 v[84:87], v[56:59], v[252:255], v[84:87]
    v_mfma_f32_16x16x32_bf16 v[88:91], v[68:71], v[248:251], v[88:91]
    v_mfma_f32_16x16x32_bf16 v[92:95], v[68:71], v[252:255], v[92:95]
    v_mfma_f32_16x16x32_bf16 v[96:99], v[60:63], v[248:251], v[96:99]
    v_mfma_f32_16x16x32_bf16 v[100:103], v[60:63], v[252:255], v[100:103]
    v_mfma_f32_16x16x32_bf16 v[104:107], v[64:67], v[248:251], v[104:107]
    v_mfma_f32_16x16x32_bf16 v[108:111], v[64:67], v[252:255], v[108:111]
    v_cvt_pk_bf16_f32 v24, v72, v73
    v_cvt_pk_bf16_f32 v25, v74, v75
    v_cvt_pk_bf16_f32 v26, v80, v81
    v_cvt_pk_bf16_f32 v27, v82, v83
    v_cvt_pk_bf16_f32 v28, v76, v77
    v_cvt_pk_bf16_f32 v29, v78, v79
    v_cvt_pk_bf16_f32 v30, v84, v85
    v_cvt_pk_bf16_f32 v31, v86, v87
    v_cvt_pk_bf16_f32 v2, v88, v89
    v_cvt_pk_bf16_f32 v3, v90, v91
    v_cvt_pk_bf16_f32 v4, v92, v93
    v_cvt_pk_bf16_f32 v5, v94, v95
    v_cndmask_b32 v50, 0, v2, s[64:65]
    v_cndmask_b32 v51, 0, v3, s[64:65]
    v_cndmask_b32 v16, 0, v4, s[64:65]
    v_cndmask_b32 v17, 0, v5, s[64:65]
    s_waitcnt lgkmcnt(1)
    v_mfma_f32_16x16x32_bf16 v[72:75], v[32:35], v[24:27], 0
    v_mov_b32 v71, 0x3f80
    v_cvt_pk_bf16_f32 v96, v96, v97
    v_mfma_f32_16x16x32_bf16 v[76:79], v[36:39], v[24:27], 0
    v_cvt_pk_bf16_f32 v97, v98, v99
    v_cvt_pk_bf16_f32 v104, v104, v105
    v_mfma_f32_16x16x32_bf16 v[80:83], v[40:43], v[24:27], 0
    v_cvt_pk_bf16_f32 v105, v106, v107
    v_cvt_pk_bf16_f32 v100, v100, v101
    v_mfma_f32_16x16x32_bf16 v[84:87], v[32:35], v[28:31], 0
    v_cvt_pk_bf16_f32 v101, v102, v103
    v_cvt_pk_bf16_f32 v108, v108, v109
    v_mfma_f32_16x16x32_bf16 v[88:91], v[36:39], v[28:31], 0
    v_cvt_pk_bf16_f32 v109, v110, v111
    ds_write_b64 v12, v[96:97] offset:192
    v_mfma_f32_16x16x32_bf16 v[92:95], v[40:43], v[28:31], 0
    ds_write_b32 v13, v104 offset:224
    ds_write_b32 v12, v105 offset:232
    v_mfma_f32_16x16x16_bf16 v[72:75], v[44:45], v[50:51], v[72:75]
    ds_write_b64 v12, v[100:101] offset:4800
    ds_write_b32 v13, v108 offset:4832
    v_mfma_f32_16x16x16_bf16 v[76:79], v[46:47], v[50:51], v[76:79]
    ds_write_b32 v12, v109 offset:4840
    v_mfma_f32_16x16x16_bf16 v[80:83], v[48:49], v[50:51], v[80:83]
    v_mfma_f32_16x16x16_bf16 v[84:87], v[44:45], v[16:17], v[84:87]
    v_mfma_f32_16x16x16_bf16 v[88:91], v[46:47], v[16:17], v[88:91]
    v_mfma_f32_16x16x16_bf16 v[92:95], v[48:49], v[16:17], v[92:95]
    s_mov_b32 exec_lo, 0
    s_mov_b32 exec_hi, 0xffff
    ds_write_b32 v12, v2 offset:244
    ds_write_b32 v12, v3 offset:248
    ds_write_b32 v12, v71 offset:212
    ds_write_b32 v12, v71 offset:252
    ds_write_b32 v12, v4 offset:4852
    ds_write_b32 v12, v5 offset:4856
    ds_write_b32 v12, v71 offset:4820
    ds_write_b32 v12, v71 offset:4860
    s_mov_b64 exec, -1
    v_max3_f32 v96, v72, v73, v74
    v_min3_f32 v97, v72, v73, v74
    v_max3_f32 v104, v84, v85, v86
    v_min3_f32 v105, v84, v85, v86
    v_max3_f32 v96, v96, v75, v76
    v_min3_f32 v97, v97, v75, v76
    v_max3_f32 v104, v104, v87, v88
    v_min3_f32 v105, v105, v87, v88
    v_max3_f32 v96, v96, v77, v78
    v_min3_f32 v97, v97, v77, v78
    v_max3_f32 v104, v104, v89, v90
    v_min3_f32 v105, v105, v89, v90
    v_max3_f32 v98, v96, v79, v80
    v_max3_f32 v96, v96, v79, v80
    v_min3_f32 v99, v97, v79, v80
    v_min3_f32 v97, v97, v79, v80
    v_max3_f32 v106, v104, v91, v92
    v_max3_f32 v104, v104, v91, v92
    v_min3_f32 v107, v105, v91, v92
    v_min3_f32 v105, v105, v91, v92
    v_permlane16_swap_b32 v96, v98
    v_permlane16_swap_b32 v97, v99
    v_permlane16_swap_b32 v104, v106
    v_permlane16_swap_b32 v105, v107
    v_max_f32 v96, v96, v98
    v_min_f32 v97, v97, v99
    v_max_f32 v104, v104, v106
    v_min_f32 v105, v105, v107
    v_mul_f32 v100, s69, v96
    v_mul_f32 v101, s68, v97
    v_mul_f32 v108, s69, v104
    v_mul_f32 v109, s68, v105
    v_pk_fma_f32 v[32:33], v[72:73], s[68:69], v[100:101] op_sel:[0,0,0] op_sel_hi:[0,1,1]
    v_pk_fma_f32 v[50:51], v[84:85], s[68:69], v[108:109] op_sel:[0,0,0] op_sel_hi:[0,1,1]
    v_pk_fma_f32 v[34:35], v[72:73], s[68:69], v[100:101] op_sel:[1,0,0] op_sel_hi:[1,1,1]
    v_pk_fma_f32 v[52:53], v[84:85], s[68:69], v[108:109] op_sel:[1,0,0] op_sel_hi:[1,1,1]
    v_pk_fma_f32 v[36:37], v[74:75], s[68:69], v[100:101] op_sel:[0,0,0] op_sel_hi:[0,1,1]
    v_pk_fma_f32 v[54:55], v[86:87], s[68:69], v[108:109] op_sel:[0,0,0] op_sel_hi:[0,1,1]
    v_pk_fma_f32 v[38:39], v[74:75], s[68:69], v[100:101] op_sel:[1,0,0] op_sel_hi:[1,1,1]
    v_pk_fma_f32 v[56:57], v[86:87], s[68:69], v[108:109] op_sel:[1,0,0] op_sel_hi:[1,1,1]
    v_pk_fma_f32 v[40:41], v[76:77], s[68:69], v[100:101] op_sel:[0,0,0] op_sel_hi:[0,1,1]
    v_pk_fma_f32 v[58:59], v[88:89], s[68:69], v[108:109] op_sel:[0,0,0] op_sel_hi:[0,1,1]
    v_pk_fma_f32 v[42:43], v[76:77], s[68:69], v[100:101] op_sel:[1,0,0] op_sel_hi:[1,1,1]
    v_pk_fma_f32 v[60:61], v[88:89], s[68:69], v[108:109] op_sel:[1,0,0] op_sel_hi:[1,1,1]
    v_pk_fma_f32 v[44:45], v[78:79], s[68:69], v[100:101] op_sel:[0,0,0] op_sel_hi:[0,1,1]
    v_pk_fma_f32 v[62:63], v[90:91], s[68:69], v[108:109] op_sel:[0,0,0] op_sel_hi:[0,1,1]
    v_pk_fma_f32 v[46:47], v[78:79], s[68:69], v[100:101] op_sel:[1,0,0] op_sel_hi:[1,1,1]
    v_pk_fma_f32 v[64:65], v[90:91], s[68:69], v[108:109] op_sel:[1,0,0] op_sel_hi:[1,1,1]
    v_pk_fma_f32 v[48:49], v[80:81], s[68:69], v[100:101] op_sel:[0,0,0] op_sel_hi:[0,1,1]
    v_pk_fma_f32 v[66:67], v[92:93], s[68:69], v[108:109] op_sel:[0,0,0] op_sel_hi:[0,1,1]
    v_exp_f32 v32, v32
    v_exp_f32 v33, v33
    v_exp_f32 v50, v50
    v_exp_f32 v51, v51
    v_exp_f32 v34, v34
    v_exp_f32 v35, v35
    v_exp_f32 v52, v52
    v_exp_f32 v53, v53
    v_exp_f32 v36, v36
    v_exp_f32 v37, v37
    v_exp_f32 v54, v54
    v_exp_f32 v55, v55
    v_pk_add_f32 v[96:97], v[32:33], v[34:35]
    v_pk_add_f32 v[104:105], v[50:51], v[52:53]
    v_exp_f32 v38, v38
    v_exp_f32 v39, v39
    v_exp_f32 v56, v56
    v_exp_f32 v57, v57
    v_pk_add_f32 v[96:97], v[96:97], v[36:37]
    v_pk_add_f32 v[104:105], v[104:105], v[54:55]
    v_exp_f32 v40, v40
    v_exp_f32 v41, v41
    v_exp_f32 v58, v58
    v_exp_f32 v59, v59
    v_pk_add_f32 v[96:97], v[96:97], v[38:39]
    v_pk_add_f32 v[104:105], v[104:105], v[56:57]
    v_exp_f32 v42, v42
    v_exp_f32 v43, v43
    v_exp_f32 v60, v60
    v_exp_f32 v61, v61
    v_pk_add_f32 v[96:97], v[96:97], v[40:41]
    v_pk_add_f32 v[104:105], v[104:105], v[58:59]
    v_exp_f32 v44, v44
    v_exp_f32 v45, v45
    v_exp_f32 v62, v62
    v_exp_f32 v63, v63
    v_pk_add_f32 v[96:97], v[96:97], v[42:43]
    v_pk_add_f32 v[104:105], v[104:105], v[60:61]
    v_exp_f32 v46, v46
    v_exp_f32 v47, v47
    v_exp_f32 v64, v64
    v_exp_f32 v65, v65
    v_pk_add_f32 v[96:97], v[96:97], v[44:45]
    v_pk_add_f32 v[104:105], v[104:105], v[62:63]
    v_exp_f32 v48, v48
    v_exp_f32 v49, v49
    v_exp_f32 v66, v66
    v_exp_f32 v67, v67
    v_pk_add_f32 v[96:97], v[96:97], v[46:47]
    v_pk_add_f32 v[104:105], v[104:105], v[64:65]
    v_pk_add_f32 v[98:99], v[96:97], v[48:49]
    v_pk_add_f32 v[96:97], v[96:97], v[48:49]
    v_pk_add_f32 v[106:107], v[104:105], v[66:67]
    v_pk_add_f32 v[104:105], v[104:105], v[66:67]
    v_mov_b32 v81, 0
    v_mov_b32 v82, 0
    v_mov_b32 v83, 0
    v_mov_b32 v93, 0
    v_mov_b32 v94, 0
    v_mov_b32 v95, 0
    v_permlane16_swap_b32 v96, v98
    v_permlane16_swap_b32 v97, v99
    v_permlane16_swap_b32 v104, v106
    v_permlane16_swap_b32 v105, v107
    v_pk_add_f32 v[96:97], v[96:97], v[98:99]
    v_pk_add_f32 v[104:105], v[104:105], v[106:107]
    v_rcp_f32 v96, v96
    v_rcp_f32 v97, v97
    v_rcp_f32 v104, v104
    v_rcp_f32 v105, v105
    v_pk_mul_f32 v[32:33], v[32:33], v[96:97]
    v_pk_mul_f32 v[34:35], v[34:35], v[96:97]
    v_pk_mul_f32 v[36:37], v[36:37], v[96:97]
    v_pk_mul_f32 v[38:39], v[38:39], v[96:97]
    v_pk_mul_f32 v[40:41], v[40:41], v[96:97]
    v_pk_mul_f32 v[42:43], v[42:43], v[96:97]
    v_pk_mul_f32 v[44:45], v[44:45], v[96:97]
    v_pk_mul_f32 v[46:47], v[46:47], v[96:97]
    v_pk_mul_f32 v[48:49], v[48:49], v[96:97]
    v_cvt_pk_bf16_f32 v72, v32, v33
    v_cvt_pk_bf16_f32 v73, v34, v35
    v_cvt_pk_bf16_f32 v74, v36, v37
    v_cvt_pk_bf16_f32 v75, v38, v39
    ds_write_b128 v6, v[72:75] offset:0
    v_cvt_pk_bf16_f32 v76, v40, v41
    v_cvt_pk_bf16_f32 v77, v42, v43
    v_cvt_pk_bf16_f32 v78, v44, v45
    v_cvt_pk_bf16_f32 v79, v46, v47
    ds_write_b128 v6, v[76:79] offset:16
    v_cvt_pk_bf16_f32 v80, v48, v49
    ds_write_b64 v6, v[80:81] offset:32
    v_pk_mul_f32 v[50:51], v[50:51], v[104:105]
    v_pk_mul_f32 v[52:53], v[52:53], v[104:105]
    v_pk_mul_f32 v[54:55], v[54:55], v[104:105]
    v_pk_mul_f32 v[56:57], v[56:57], v[104:105]
    v_pk_mul_f32 v[58:59], v[58:59], v[104:105]
    v_pk_mul_f32 v[60:61], v[60:61], v[104:105]
    v_pk_mul_f32 v[62:63], v[62:63], v[104:105]
    v_pk_mul_f32 v[64:65], v[64:65], v[104:105]
    v_pk_mul_f32 v[66:67], v[66:67], v[104:105]
    v_cvt_pk_bf16_f32 v84, v50, v51
    v_cvt_pk_bf16_f32 v85, v52, v53
    v_cvt_pk_bf16_f32 v86, v54, v55
    v_cvt_pk_bf16_f32 v87, v56, v57
    ds_write_b128 v6, v[84:87] offset:4608
    v_cvt_pk_bf16_f32 v88, v58, v59
    v_cvt_pk_bf16_f32 v89, v60, v61
    v_cvt_pk_bf16_f32 v90, v62, v63
    v_cvt_pk_bf16_f32 v91, v64, v65
    ds_write_b128 v6, v[88:91] offset:4624
    v_cvt_pk_bf16_f32 v92, v66, v67
    ds_write_b64 v6, v[92:93] offset:4640
    v_mov_b32 v22, 5
    ds_write_b32 v19, v22
    ds_read_b128 v[28:31], v18 offset:16
    s_mov_b32 s59, 0
Lw_12:
    ds_read_b128 v[24:27], v18 offset:0
    s_add_u32 s59, s59, 1
    s_waitcnt lgkmcnt(0)
    v_min_u32 v24, v24, v25
    v_min3_u32 v24, v24, v26, v27
    v_cmp_gt_u32 vcc, 5, v24
    s_cmp_gt_u32 s59, 1000000
    s_cbranch_scc1 Lx_13
    s_cbranch_vccnz Lw_12
Lx_13:
    ds_read_b64_tr_b16 v[32:33], v7 offset:0
    ds_read_b64_tr_b16 v[34:35], v7 offset:4608
    ds_read_b64_tr_b16 v[36:37], v8 offset:0
    ds_read_b64_tr_b16 v[38:39], v8 offset:4608
    ds_read_b64_tr_b16 v[40:41], v9 offset:0
    ds_read_b64_tr_b16 v[42:43], v9 offset:4608
    ds_read_b64_tr_b16 v[44:45], v10 offset:0
    ds_read_b64_tr_b16 v[46:47], v10 offset:4608
    ds_read_b64_tr_b16 v[48:49], v7 offset:9216
    ds_read_b64_tr_b16 v[50:51], v7 offset:13824
    ds_read_b64_tr_b16 v[52:53], v8 offset:9216
    ds_read_b64_tr_b16 v[54:55], v8 offset:13824
    ds_read_b64_tr_b16 v[56:57], v9 offset:9216
    ds_read_b64_tr_b16 v[58:59], v9 offset:13824
    ds_read_b64_tr_b16 v[60:61], v10 offset:9216
    ds_read_b64_tr_b16 v[62:63], v10 offset:13824
    s_waitcnt lgkmcnt(8)
    v_mfma_f32_16x16x32_bf16 v[96:99], v[32:35], v[44:47], 0
    v_mfma_f32_16x16x32_bf16 v[100:103], v[36:39], v[44:47], 0
    v_mfma_f32_16x16x32_bf16 v[104:107], v[40:43], v[44:47], 0
    ds_read_b64_tr_b16 v[64:65], v7 offset:18432
    ds_read_b64_tr_b16 v[66:67], v7 offset:23040
    ds_read_b64_tr_b16 v[68:69], v8 offset:18432
    ds_read_b64_tr_b16 v[70:71], v8 offset:23040
    ds_read_b64_tr_b16 v[72:73], v9 offset:18432
    ds_read_b64_tr_b16 v[74:75], v9 offset:23040
    ds_read_b64_tr_b16 v[76:77], v10 offset:18432
    ds_read_b64_tr_b16 v[78:79], v10 offset:23040
    s_waitcnt lgkmcnt(8)
    v_mfma_f32_16x16x32_bf16 v[96:99], v[48:51], v[60:63], v[96:99]
    v_mfma_f32_16x16x32_bf16 v[100:103], v[52:55], v[60:63], v[100:103]
    v_mfma_f32_16x16x32_bf16 v[104:107], v[56:59], v[60:63], v[104:107]
    ds_read_b64_tr_b16 v[80:81], v7 offset:27648
    ds_read_b64_tr_b16 v[82:83], v7 offset:32256
    ds_read_b64_tr_b16 v[84:85], v8 offset:27648
    ds_read_b64_tr_b16 v[86:87], v8 offset:32256
    ds_read_b64_tr_b16 v[88:89], v9 offset:27648
    ds_read_b64_tr_b16 v[90:91], v9 offset:32256
    ds_read_b64_tr_b16 v[92:93], v10 offset:27648
    ds_read_b64_tr_b16 v[94:95], v10 offset:32256
    s_waitcnt lgkmcnt(8)
    v_mfma_f32_16x16x32_bf16 v[96:99], v[64:67], v[76:79], v[96:99]
    v_mfma_f32_16x16x32_bf16 v[100:103], v[68:71], v[76:79], v[100:103]
    v_mfma_f32_16x16x32_bf16 v[104:107], v[72:75], v[76:79], v[104:107]
    v_add_u32 v21, 92160, v1
    s_waitcnt lgkmcnt(0)
    v_mfma_f32_16x16x32_bf16 v[96:99], v[80:83], v[92:95], v[96:99]
    v_mfma_f32_16x16x32_bf16 v[100:103], v[84:87], v[92:95], v[100:103]
    v_mfma_f32_16x16x32_bf16 v[104:107], v[88:91], v[92:95], v[104:107]
    v_mov_b32 v22, 6
    ds_write_b32 v19, v22
    s_waitcnt lgkmcnt(1)
    v_min_u32 v28, v28, v29
    v_min3_u32 v28, v28, v30, v31
    v_cmp_gt_u32 vcc, 3, v28
    s_cbranch_vccz Lk_15
    s_mov_b32 s59, 0
Lw_16:
    ds_read_b128 v[28:31], v18 offset:16
    s_add_u32 s59, s59, 1
    s_waitcnt lgkmcnt(0)
    v_min_u32 v28, v28, v29
    v_min3_u32 v28, v28, v30, v31
    v_cmp_gt_u32 vcc, 3, v28
    s_cmp_gt_u32 s59, 1000000
    s_cbranch_scc1 Lx_17
    s_cbranch_vccnz Lw_16
Lx_17:
Lk_15:
    ds_read_b128 v[52:55], v21 offset:0
    ds_read_b128 v[56:59], v21 offset:1024
    ds_read_b128 v[60:63], v21 offset:2048
    ds_read_b128 v[64:67], v21 offset:3072
    v_cvt_pk_bf16_f32 v96, v96, v97
    v_cvt_pk_bf16_f32 v97, v98, v99
    buffer_store_dwordx2 v[96:97], v11, s[40:43], s51 offen sc1
    s_add_u32 s51, s51, s52
    v_cvt_pk_bf16_f32 v100, v100, v101
    v_cvt_pk_bf16_f32 v101, v102, v103
    buffer_store_dwordx2 v[100:101], v11, s[40:43], s51 offen sc1
    s_add_u32 s51, s51, s52
    v_cvt_pk_bf16_f32 v104, v104, v105
    v_cvt_pk_bf16_f32 v105, v106, v107
    s_mov_b32 exec_hi, 0
    buffer_store_dwordx2 v[104:105], v11, s[40:43], s51 offen sc1
    s_add_u32 s51, s51, s52
    s_mov_b64 exec, -1
    ds_read_b128 v[88:91], v21 offset:4096
    ds_read_b128 v[92:95], v21 offset:5120
    s_waitcnt lgkmcnt(4)
    v_mfma_f32_16x16x32_bf16 v[72:75], v[52:55], v[112:115], 0
    s_mul_i32 s57, s45, 248832
    v_mfma_f32_16x16x32_bf16 v[76:79], v[52:55], v[116:119], 0
    s_add_u32 s57, s57, 2230272
    s_lshl_b32 s58, s4, 12
    v_mfma_f32_16x16x32_bf16 v[80:83], v[56:59], v[112:115], 0
    s_add_u32 s57, s57, s58
    v_mfma_f32_16x16x32_bf16 v[84:87], v[56:59], v[116:119], 0
    v_mul_u32_u24 v68, 3200, v15
    v_lshl_add_u32 v68, v14, 4, v68
    ds_read_b128 v[52:55], v21 offset:6144
    ds_read_b128 v[56:59], v21 offset:7168
    s_waitcnt lgkmcnt(4)
    ds_read_b128 v[24:27], v18 offset:0
    v_mfma_f32_16x16x32_bf16 v[72:75], v[60:63], v[120:123], v[72:75]
    s_mul_i32 s62, s6, 51200
    v_mfma_f32_16x16x32_bf16 v[76:79], v[60:63], v[124:127], v[76:79]
    s_lshl_b32 s63, s4, 10
    s_add_u32 s62, s62, s63
    v_mfma_f32_16x16x32_bf16 v[80:83], v[64:67], v[120:123], v[80:83]
    s_add_u32 s62, s62, 11296768
    v_mfma_f32_16x16x32_bf16 v[84:87], v[64:67], v[124:127], v[84:87]
    v_add_u32 v68, s62, v68
    v_cmp_lt_u32 s[72:73], 7, v14
    ds_read_b128 v[60:63], v21 offset:8192
    ds_read_b128 v[64:67], v21 offset:9216
    s_waitcnt lgkmcnt(4)
    v_mfma_f32_16x16x32_bf16 v[72:75], v[88:91], v[128:131], v[72:75]
    v_mov_b32 v28, 1073741824
    v_mfma_f32_16x16x32_bf16 v[76:79], v[88:91], v[132:135], v[76:79]
    s_cmp_eq_u32 s4, 3
    s_cselect_b64 s[74:75], -1, 0
    v_cndmask_b32 v69, v68, v28, s[74:75]
    v_mfma_f32_16x16x32_bf16 v[80:83], v[92:95], v[128:131], v[80:83]
    s_and_b64 s[74:75], s[74:75], s[72:73]
    v_mfma_f32_16x16x32_bf16 v[84:87], v[92:95], v[132:135], v[84:87]
    v_cndmask_b32 v68, v68, v28, s[74:75]
    v_lshrrev_b32 v28, 1, v15
    ds_read_b128 v[88:91], v21 offset:10240
    ds_read_b128 v[92:95], v21 offset:11264
    s_waitcnt lgkmcnt(4)
    v_mfma_f32_16x16x32_bf16 v[72:75], v[52:55], v[136:139], v[72:75]
    v_lshlrev_b32 v29, 8, v28
    v_mfma_f32_16x16x32_bf16 v[76:79], v[52:55], v[140:143], v[76:79]
    v_lshl_add_u32 v29, v14, 4, v29
    v_and_b32 v30, 1, v15
    v_mfma_f32_16x16x32_bf16 v[80:83], v[56:59], v[136:139], v[80:83]
    v_lshl_add_u32 v29, v30, 3, v29
    v_mfma_f32_16x16x32_bf16 v[84:87], v[56:59], v[140:143], v[84:87]
    s_add_u32 s63, s63, 82944
    v_add_u32 v70, s63, v29
    ds_read_b128 v[52:55], v21 offset:12288
    ds_read_b128 v[56:59], v21 offset:13312
    s_waitcnt lgkmcnt(4)
    s_waitcnt lgkmcnt(4)
    v_min_u32 v24, v24, v25
    v_min3_u32 v24, v24, v26, v27
    v_cmp_gt_u32 vcc, 6, v24
    s_cbranch_vccz Lk_19
    s_mov_b32 s59, 0
Lw_20:
    ds_read_b128 v[24:27], v18 offset:0
    s_add_u32 s59, s59, 1
    s_waitcnt lgkmcnt(0)
    v_min_u32 v24, v24, v25
    v_min3_u32 v24, v24, v26, v27
    v_cmp_gt_u32 vcc, 6, v24
    s_cmp_gt_u32 s59, 1000000
    s_cbranch_scc1 Lx_21
    s_cbranch_vccnz Lw_20
Lx_21:
Lk_19:
    v_mfma_f32_16x16x32_bf16 v[72:75], v[60:63], v[144:147], v[72:75]
    v_lshrrev_b32 v29, 3, v14
    s_add_u32 m0, s58, 0
    v_mfma_f32_16x16x32_bf16 v[76:79], v[60:63], v[148:151], v[76:79]
    v_cmp_eq_u32 s[72:73], v28, v29
    v_and_b32 v29, 3, v14
    v_mfma_f32_16x16x32_bf16 v[80:83], v[64:67], v[144:147], v[80:83]
    v_bfe_u32 v30, v14, 2, 1
    s_add_u32 s53, s57, 0
    v_mfma_f32_16x16x32_bf16 v[84:87], v[64:67], v[148:151], v[84:87]
    v_mul_u32_u24 v31, 640, v15
    v_lshl_add_u32 v31, v30, 6, v31
    ds_read_b128 v[60:63], v21 offset:14336
    ds_read_b128 v[64:67], v21 offset:15360
    s_waitcnt lgkmcnt(4)
    v_mfma_f32_16x16x32_bf16 v[72:75], v[88:91], v[152:155], v[72:75]
    v_lshl_add_u32 v31, v29, 3, v31
    buffer_load_dwordx4 v1, s[40:43], s53 offen offset:0 sc1 lds
    v_mfma_f32_16x16x32_bf16 v[76:79], v[88:91], v[156:159], v[76:79]
    v_mov_b32 v28, 3200
    v_cndmask_b32 v31, v28, v31, s[72:73]
    v_mfma_f32_16x16x32_bf16 v[80:83], v[92:95], v[152:155], v[80:83]
    v_add_u32 v9, 82944, v31
    buffer_load_dwordx4 v1, s[40:43], s53 offen offset:1024 sc1 lds
    v_mfma_f32_16x16x32_bf16 v[84:87], v[92:95], v[156:159], v[84:87]
    v_mul_u32_u24 v30, 160, v15
    v_lshl_add_u32 v30, v29, 3, v30
    ds_read_b128 v[88:91], v21 offset:16384
    ds_read_b128 v[92:95], v21 offset:17408
    s_waitcnt lgkmcnt(4)
    v_mfma_f32_16x16x32_bf16 v[72:75], v[52:55], v[160:163], v[72:75]
    v_add_u32 v30, 2560, v30
    buffer_load_dwordx4 v1, s[40:43], s53 offen offset:2048 sc1 lds
    v_mfma_f32_16x16x32_bf16 v[76:79], v[52:55], v[164:167], v[76:79]
    v_cndmask_b32 v30, v28, v30, s[72:73]
    v_add_u32 v10, 82944, v30
    v_mfma_f32_16x16x32_bf16 v[80:83], v[56:59], v[160:163], v[80:83]
    s_lshl_b32 s62, s5, 3
    buffer_load_dwordx4 v1, s[40:43], s53 offen offset:3072 sc1 lds
    v_mfma_f32_16x16x32_bf16 v[84:87], v[56:59], v[164:167], v[84:87]
    s_lshl_b32 s63, s4, 1
    s_add_u32 s62, s62, s63
    ds_read_b128 v[52:55], v21 offset:18432
    ds_read_b128 v[56:59], v21 offset:19456
    s_waitcnt lgkmcnt(4)
    v_mfma_f32_16x16x32_bf16 v[72:75], v[60:63], v[168:171], v[72:75]
    s_mul_i32 s62, s62, 18432
    s_add_u32 m0, s58, 16384
    v_mfma_f32_16x16x32_bf16 v[76:79], v[60:63], v[172:175], v[76:79]
    s_add_u32 s62, s62, 8773632
    s_lshl_b32 s51, s6, 10
    v_mfma_f32_16x16x32_bf16 v[80:83], v[64:67], v[168:171], v[80:83]
    s_add_u32 s51, s51, s62
    s_add_u32 s53, s57, 16384
    v_mfma_f32_16x16x32_bf16 v[84:87], v[64:67], v[172:175], v[84:87]
    s_add_u32 s52, s51, 18432
    s_lshl_b32 s15, s6, 7
    ds_read_b128 v[60:63], v21 offset:20480
    ds_read_b128 v[64:67], v21 offset:21504
    s_waitcnt lgkmcnt(4)
    v_mfma_f32_16x16x32_bf16 v[72:75], v[88:91], v[176:179], v[72:75]
    s_add_u32 s15, s15, s62
    buffer_load_dwordx4 v1, s[40:43], s53 offen offset:0 sc1 lds
    v_mfma_f32_16x16x32_bf16 v[76:79], v[88:91], v[180:183], v[76:79]
    s_add_u32 s15, s15, 16384
    v_mfma_f32_16x16x32_bf16 v[80:83], v[92:95], v[176:179], v[80:83]
    v_lshrrev_b32 v11, 5, v0
    buffer_load_dwordx4 v1, s[40:43], s53 offen offset:1024 sc1 lds
    v_mfma_f32_16x16x32_bf16 v[84:87], v[92:95], v[180:183], v[84:87]
    v_mul_u32_u24 v11, 18432, v11
    ds_read_b128 v[88:91], v21 offset:22528
    ds_read_b128 v[92:95], v21 offset:23552
    s_waitcnt lgkmcnt(4)
    v_mfma_f32_16x16x32_bf16 v[72:75], v[52:55], v[184:187], v[72:75]
    v_lshl_add_u32 v11, v14, 3, v11
    buffer_load_dwordx4 v1, s[40:43], s53 offen offset:2048 sc1 lds
    ds_read_b128 v[32:35], v20 offset:0
    v_mfma_f32_16x16x32_bf16 v[76:79], v[52:55], v[188:191], v[76:79]
    s_lshl_b32 s54, s5, 1
    v_mfma_f32_16x16x32_bf16 v[80:83], v[56:59], v[184:187], v[80:83]
    s_lshr_b32 s63, s4, 1
    buffer_load_dwordx4 v1, s[40:43], s53 offen offset:3072 sc1 lds
    v_mfma_f32_16x16x32_bf16 v[84:87], v[56:59], v[188:191], v[84:87]
    s_add_u32 s54, s54, s63
    ds_read_b128 v[52:55], v21 offset:24576
    ds_read_b128 v[56:59], v21 offset:25600
    s_waitcnt lgkmcnt(4)
    v_mfma_f32_16x16x32_bf16 v[72:75], v[60:63], v[192:195], v[72:75]
    s_lshl_b32 s54, s54, 12
    ds_read_b128 v[36:39], v20 offset:1024
    v_mfma_f32_16x16x32_bf16 v[76:79], v[60:63], v[196:199], v[76:79]
    s_and_b32 s62, s4, 1
    v_mfma_f32_16x16x32_bf16 v[80:83], v[64:67], v[192:195], v[80:83]
    s_lshl_b32 s62, s62, 7
    v_mfma_f32_16x16x32_bf16 v[84:87], v[64:67], v[196:199], v[84:87]
    s_add_u32 s54, s54, s62
    ds_read_b128 v[60:63], v21 offset:26624
    ds_read_b128 v[64:67], v21 offset:27648
    s_waitcnt lgkmcnt(4)
    v_mfma_f32_16x16x32_bf16 v[72:75], v[88:91], v[200:203], v[72:75]
    s_lshl_b32 s62, s6, 3
    ds_read_b128 v[40:43], v20 offset:2048
    v_mfma_f32_16x16x32_bf16 v[76:79], v[88:91], v[204:207], v[76:79]
    s_add_u32 s54, s54, s62
    v_mfma_f32_16x16x32_bf16 v[80:83], v[92:95], v[200:203], v[80:83]
    s_add_u32 s54, s54, 12222720
    v_mfma_f32_16x16x32_bf16 v[84:87], v[92:95], v[204:207], v[84:87]
    s_lshl_b32 s55, s44, 2
    ds_read_b128 v[88:91], v21 offset:28672
    ds_read_b128 v[92:95], v21 offset:29696
    s_waitcnt lgkmcnt(4)
    v_mfma_f32_16x16x32_bf16 v[72:75], v[52:55], v[208:211], v[72:75]
    s_add_u32 s55, s55, s4
    ds_read_b64 v[44:45], v23 offset:0
    v_mfma_f32_16x16x32_bf16 v[76:79], v[52:55], v[212:215], v[76:79]
    s_lshl_b32 s62, s44, 3
    v_mfma_f32_16x16x32_bf16 v[80:83], v[56:59], v[208:211], v[80:83]
    s_add_u32 s62, s62, s45
    v_mfma_f32_16x16x32_bf16 v[84:87], v[56:59], v[212:215], v[84:87]
    s_lshl_b32 s62, s62, 2
    ds_read_b128 v[52:55], v21 offset:30720
    ds_read_b128 v[56:59], v21 offset:31744
    s_waitcnt lgkmcnt(4)
    v_mfma_f32_16x16x32_bf16 v[72:75], v[60:63], v[216:219], v[72:75]
    s_add_u32 s62, s62, s63
    ds_read_b64 v[46:47], v23 offset:512
    v_mfma_f32_16x16x32_bf16 v[76:79], v[60:63], v[220:223], v[76:79]
    s_lshl_b32 s62, s62, 7
    v_mfma_f32_16x16x32_bf16 v[80:83], v[64:67], v[216:219], v[80:83]
    s_add_u32 s62, s62, 12222720
    v_mfma_f32_16x16x32_bf16 v[84:87], v[64:67], v[220:223], v[84:87]
    s_mul_i32 s56, s55, 18432
    ds_read_b128 v[60:63], v21 offset:32768
    ds_read_b128 v[64:67], v21 offset:33792
    s_waitcnt lgkmcnt(4)
    v_mfma_f32_16x16x32_bf16 v[72:75], v[88:91], v[224:227], v[72:75]
    s_add_u32 s56, s56, 8773632
    ds_read_b64 v[48:49], v23 offset:1024
    v_mfma_f32_16x16x32_bf16 v[76:79], v[88:91], v[228:231], v[76:79]
    s_add_u32 s12, s40, s62
    s_addc_u32 s13, s41, 0
    v_mfma_f32_16x16x32_bf16 v[80:83], v[92:95], v[224:227], v[80:83]
    v_lshlrev_b32 v12, 7, v15
    v_mfma_f32_16x16x32_bf16 v[84:87], v[92:95], v[228:231], v[84:87]
    v_and_b32 v29, 7, v0
    ds_read_b128 v[88:91], v21 offset:34816
    ds_read_b128 v[92:95], v21 offset:35840
    s_waitcnt lgkmcnt(4)
    v_mfma_f32_16x16x32_bf16 v[72:75], v[52:55], v[232:235], v[72:75]
    v_lshl_add_u32 v12, v29, 4, v12
    v_mfma_f32_16x16x32_bf16 v[76:79], v[52:55], v[236:239], v[76:79]
    v_add_u32 v12, 4096, v12
    v_mfma_f32_16x16x32_bf16 v[80:83], v[56:59], v[232:235], v[80:83]
    v_add_u32 v13, 41472, v12
    v_mfma_f32_16x16x32_bf16 v[84:87], v[56:59], v[236:239], v[84:87]
    v_lshlrev_b32 v8, 3, v0
    s_waitcnt lgkmcnt(2)
    v_mfma_f32_16x16x32_bf16 v[72:75], v[60:63], v[240:243], v[72:75]
    v_add_u32 v7, 41472, v1
    v_mfma_f32_16x16x32_bf16 v[76:79], v[60:63], v[244:247], v[76:79]
    s_mul_i32 s62, s4, 4608
    v_mfma_f32_16x16x32_bf16 v[80:83], v[64:67], v[240:243], v[80:83]
    v_mul_u32_u24 v6, 288, v14
    v_mfma_f32_16x16x32_bf16 v[84:87], v[64:67], v[244:247], v[84:87]
    v_lshl_add_u32 v6, v15, 4, v6
    s_waitcnt lgkmcnt(0)
    v_mfma_f32_16x16x32_bf16 v[72:75], v[88:91], v[248:251], v[72:75]
    v_add_u32 v6, s62, v6
    v_mfma_f32_16x16x32_bf16 v[76:79], v[88:91], v[252:255], v[76:79]
    v_lshlrev_b32 v22, 9, v0
    v_mfma_f32_16x16x32_bf16 v[80:83], v[92:95], v[248:251], v[80:83]
    v_mfma_f32_16x16x32_bf16 v[84:87], v[92:95], v[252:255], v[84:87]
    s_nop 2
    v_cvt_pk_bf16_f32 v24, v72, v73
    v_cvt_pk_bf16_f32 v25, v74, v75
    s_nop 1
    v_cvt_pk_bf16_f32 v26, v80, v81
    v_cvt_pk_bf16_f32 v27, v82, v83
    v_cvt_pk_bf16_f32 v28, v76, v77
    v_cvt_pk_bf16_f32 v29, v78, v79
    v_cvt_pk_bf16_f32 v30, v84, v85
    v_cvt_pk_bf16_f32 v31, v86, v87
    v_cndmask_b32 v50, 0, v2, s[66:67]
    v_cndmask_b32 v51, 0, v3, s[66:67]
    v_cndmask_b32 v16, 0, v4, s[66:67]
    v_cndmask_b32 v17, 0, v5, s[66:67]
    s_waitcnt lgkmcnt(0)
    v_mfma_f32_16x16x32_bf16 v[72:75], v[32:35], v[24:27], 0
    v_mov_b32 v52, 0x3f80
    v_and_b32 v53, 1, v14
    v_mfma_f32_16x16x32_bf16 v[76:79], v[36:39], v[24:27], 0
    v_lshlrev_b32 v53, 4, v53
    v_lshlrev_b32 v53, v53, v52
    v_mfma_f32_16x16x32_bf16 v[80:83], v[40:43], v[24:27], 0
    v_lshrrev_b32 v54, 1, v14
    v_cmp_eq_u32 s[22:23], 0, v54
    v_mfma_f32_16x16x32_bf16 v[84:87], v[32:35], v[28:31], 0
    v_cmp_eq_u32 s[24:25], 1, v54
    v_cmp_eq_u32 s[26:27], 2, v54
    v_mfma_f32_16x16x32_bf16 v[88:91], v[36:39], v[28:31], 0
    v_cmp_eq_u32 s[28:29], 3, v54
    v_cndmask_b32 v176, 0, v53, s[22:23]
    v_mfma_f32_16x16x32_bf16 v[92:95], v[40:43], v[28:31], 0
    v_cndmask_b32 v177, 0, v53, s[24:25]
    v_cndmask_b32 v178, 0, v53, s[26:27]
    v_mfma_f32_16x16x16_bf16 v[72:75], v[44:45], v[50:51], v[72:75]
    v_cndmask_b32 v179, 0, v53, s[28:29]
    v_cmp_eq_u32 s[22:23], 4, v54
    v_mfma_f32_16x16x16_bf16 v[76:79], v[46:47], v[50:51], v[76:79]
    v_cmp_eq_u32 s[24:25], 5, v54
    v_cmp_eq_u32 s[26:27], 6, v54
    v_mfma_f32_16x16x16_bf16 v[80:83], v[48:49], v[50:51], v[80:83]
    v_cmp_eq_u32 s[28:29], 7, v54
    v_cndmask_b32 v180, 0, v53, s[22:23]
    v_mfma_f32_16x16x16_bf16 v[84:87], v[44:45], v[16:17], v[84:87]
    v_cndmask_b32 v181, 0, v53, s[24:25]
    v_cndmask_b32 v182, 0, v53, s[26:27]
    v_mfma_f32_16x16x16_bf16 v[88:91], v[46:47], v[16:17], v[88:91]
    v_cndmask_b32 v183, 0, v53, s[28:29]
    v_mfma_f32_16x16x16_bf16 v[92:95], v[48:49], v[16:17], v[92:95]
    v_max3_f32 v96, v72, v73, v74
    v_min3_f32 v97, v72, v73, v74
    s_nop 0
    v_max3_f32 v104, v84, v85, v86
    v_min3_f32 v105, v84, v85, v86
    s_mov_b32 s62, 0
    v_max3_f32 v96, v96, v75, v76
    v_min3_f32 v97, v97, v75, v76
    v_max3_f32 v104, v104, v87, v88
    v_min3_f32 v105, v105, v87, v88
    v_max3_f32 v96, v96, v77, v78
    buffer_load_dwordx4 v[112:115], v68, s[40:43], s62 offen offset:0 sc1
    v_min3_f32 v97, v97, v77, v78
    v_max3_f32 v104, v104, v89, v90
    v_min3_f32 v105, v105, v89, v90
    v_max3_f32 v98, v96, v79, v80
    v_max3_f32 v96, v96, v79, v80
    buffer_load_dwordx4 v[116:119], v69, s[40:43], s62 offen offset:256 sc1
    v_min3_f32 v99, v97, v79, v80
    v_min3_f32 v97, v97, v79, v80
    v_max3_f32 v106, v104, v91, v92
    v_max3_f32 v104, v104, v91, v92
    v_min3_f32 v107, v105, v91, v92
    buffer_load_dwordx4 v[120:123], v69, s[40:43], s62 offen offset:512 sc1
    v_min3_f32 v105, v105, v91, v92
    v_permlane16_swap_b32 v96, v98
    v_permlane16_swap_b32 v97, v99
    v_permlane16_swap_b32 v104, v106
    v_permlane16_swap_b32 v105, v107
    buffer_load_dwordx4 v[124:127], v69, s[40:43], s62 offen offset:768 sc1
    v_max_f32 v96, v96, v98
    v_min_f32 v97, v97, v99
    v_max_f32 v104, v104, v106
    v_min_f32 v105, v105, v107
    v_mul_f32 v100, s69, v96
    s_mov_b32 s62, 12800
    v_mul_f32 v101, s68, v97
    v_mul_f32 v108, s69, v104
    v_mul_f32 v109, s68, v105
    v_pk_fma_f32 v[32:33], v[72:73], s[68:69], v[100:101] op_sel:[0,0,0] op_sel_hi:[0,1,1]
    v_pk_fma_f32 v[50:51], v[84:85], s[68:69], v[108:109] op_sel:[0,0,0] op_sel_hi:[0,1,1]
    buffer_load_dwordx4 v[128:131], v68, s[40:43], s62 offen offset:0 sc1
    v_pk_fma_f32 v[34:35], v[72:73], s[68:69], v[100:101] op_sel:[1,0,0] op_sel_hi:[1,1,1]
    v_pk_fma_f32 v[52:53], v[84:85], s[68:69], v[108:109] op_sel:[1,0,0] op_sel_hi:[1,1,1]
    v_pk_fma_f32 v[36:37], v[74:75], s[68:69], v[100:101] op_sel:[0,0,0] op_sel_hi:[0,1,1]
    v_pk_fma_f32 v[54:55], v[86:87], s[68:69], v[108:109] op_sel:[0,0,0] op_sel_hi:[0,1,1]
    v_pk_fma_f32 v[38:39], v[74:75], s[68:69], v[100:101] op_sel:[1,0,0] op_sel_hi:[1,1,1]
    buffer_load_dwordx4 v[132:135], v69, s[40:43], s62 offen offset:256 sc1
    v_pk_fma_f32 v[56:57], v[86:87], s[68:69], v[108:109] op_sel:[1,0,0] op_sel_hi:[1,1,1]
    v_pk_fma_f32 v[40:41], v[76:77], s[68:69], v[100:101] op_sel:[0,0,0] op_sel_hi:[0,1,1]
    v_pk_fma_f32 v[58:59], v[88:89], s[68:69], v[108:109] op_sel:[0,0,0] op_sel_hi:[0,1,1]
    v_pk_fma_f32 v[42:43], v[76:77], s[68:69], v[100:101] op_sel:[1,0,0] op_sel_hi:[1,1,1]
    v_pk_fma_f32 v[60:61], v[88:89], s[68:69], v[108:109] op_sel:[1,0,0] op_sel_hi:[1,1,1]
    buffer_load_dwordx4 v[136:139], v69, s[40:43], s62 offen offset:512 sc1
    v_pk_fma_f32 v[44:45], v[78:79], s[68:69], v[100:101] op_sel:[0,0,0] op_sel_hi:[0,1,1]
    v_pk_fma_f32 v[62:63], v[90:91], s[68:69], v[108:109] op_sel:[0,0,0] op_sel_hi:[0,1,1]
    v_pk_fma_f32 v[46:47], v[78:79], s[68:69], v[100:101] op_sel:[1,0,0] op_sel_hi:[1,1,1]
    v_pk_fma_f32 v[64:65], v[90:91], s[68:69], v[108:109] op_sel:[1,0,0] op_sel_hi:[1,1,1]
    v_pk_fma_f32 v[48:49], v[80:81], s[68:69], v[100:101] op_sel:[0,0,0] op_sel_hi:[0,1,1]
    buffer_load_dwordx4 v[140:143], v69, s[40:43], s62 offen offset:768 sc1
    v_pk_fma_f32 v[66:67], v[92:93], s[68:69], v[108:109] op_sel:[0,0,0] op_sel_hi:[0,1,1]
    v_exp_f32 v32, v32
    v_exp_f32 v33, v33
    v_exp_f32 v50, v50
    v_exp_f32 v51, v51
    s_mov_b32 s62, 25600
    v_exp_f32 v34, v34
    v_exp_f32 v35, v35
    v_exp_f32 v52, v52
    v_exp_f32 v53, v53
    v_exp_f32 v36, v36
    buffer_load_dwordx4 v[144:147], v68, s[40:43], s62 offen offset:0 sc1
    v_exp_f32 v37, v37
    v_exp_f32 v54, v54
    v_exp_f32 v55, v55
    v_pk_add_f32 v[96:97], v[32:33], v[34:35]
    v_pk_add_f32 v[104:105], v[50:51], v[52:53]
    buffer_load_dwordx4 v[148:151], v69, s[40:43], s62 offen offset:256 sc1
    v_exp_f32 v38, v38
    v_exp_f32 v39, v39
    v_exp_f32 v56, v56
    v_exp_f32 v57, v57
    v_pk_add_f32 v[96:97], v[96:97], v[36:37]
    buffer_load_dwordx4 v[152:155], v69, s[40:43], s62 offen offset:512 sc1
    v_pk_add_f32 v[104:105], v[104:105], v[54:55]
    v_exp_f32 v40, v40
    v_exp_f32 v41, v41
    v_exp_f32 v58, v58
    v_exp_f32 v59, v59
    buffer_load_dwordx4 v[156:159], v69, s[40:43], s62 offen offset:768 sc1
    v_pk_add_f32 v[96:97], v[96:97], v[38:39]
    v_pk_add_f32 v[104:105], v[104:105], v[56:57]
    v_exp_f32 v42, v42
    v_exp_f32 v43, v43
    v_exp_f32 v60, v60
    s_mov_b32 s62, 38400
    v_exp_f32 v61, v61
    v_pk_add_f32 v[96:97], v[96:97], v[40:41]
    v_pk_add_f32 v[104:105], v[104:105], v[58:59]
    v_exp_f32 v44, v44
    v_exp_f32 v45, v45
    buffer_load_dwordx4 v[160:163], v68, s[40:43], s62 offen offset:0 sc1
    v_exp_f32 v62, v62
    v_exp_f32 v63, v63
    v_pk_add_f32 v[96:97], v[96:97], v[42:43]
    v_pk_add_f32 v[104:105], v[104:105], v[60:61]
    v_exp_f32 v46, v46
    buffer_load_dwordx4 v[164:167], v69, s[40:43], s62 offen offset:256 sc1
    v_exp_f32 v47, v47
    v_exp_f32 v64, v64
    v_exp_f32 v65, v65
    v_pk_add_f32 v[96:97], v[96:97], v[44:45]
    v_pk_add_f32 v[104:105], v[104:105], v[62:63]
    buffer_load_dwordx4 v[168:171], v69, s[40:43], s62 offen offset:512 sc1
    v_exp_f32 v48, v48
    v_exp_f32 v49, v49
    v_exp_f32 v66, v66
    v_exp_f32 v67, v67
    v_pk_add_f32 v[96:97], v[96:97], v[46:47]
    buffer_load_dwordx4 v[172:175], v69, s[40:43], s62 offen offset:768 sc1
    v_pk_add_f32 v[104:105], v[104:105], v[64:65]
    v_pk_add_f32 v[98:99], v[96:97], v[48:49]
    v_pk_add_f32 v[96:97], v[96:97], v[48:49]
    v_pk_add_f32 v[106:107], v[104:105], v[66:67]
    v_pk_add_f32 v[104:105], v[104:105], v[66:67]
    v_mov_b32 v81, 0
    v_mov_b32 v82, 0
    v_mov_b32 v83, 0
    v_mov_b32 v93, 0
    v_mov_b32 v94, 0
    v_mov_b32 v95, 0
    v_permlane16_swap_b32 v96, v98
    v_permlane16_swap_b32 v97, v99
    v_permlane16_swap_b32 v104, v106
    v_permlane16_swap_b32 v105, v107
    v_pk_add_f32 v[96:97], v[96:97], v[98:99]
    v_pk_add_f32 v[104:105], v[104:105], v[106:107]
    v_rcp_f32 v96, v96
    v_rcp_f32 v97, v97
    v_rcp_f32 v104, v104
    v_rcp_f32 v105, v105
    v_pk_mul_f32 v[32:33], v[32:33], v[96:97]
    v_pk_mul_f32 v[34:35], v[34:35], v[96:97]
    v_pk_mul_f32 v[36:37], v[36:37], v[96:97]
    v_pk_mul_f32 v[38:39], v[38:39], v[96:97]
    v_pk_mul_f32 v[40:41], v[40:41], v[96:97]
    v_pk_mul_f32 v[42:43], v[42:43], v[96:97]
    v_pk_mul_f32 v[44:45], v[44:45], v[96:97]
    v_pk_mul_f32 v[46:47], v[46:47], v[96:97]
    v_pk_mul_f32 v[48:49], v[48:49], v[96:97]
    v_cvt_pk_bf16_f32 v72, v32, v33
    v_cvt_pk_bf16_f32 v73, v34, v35
    v_cvt_pk_bf16_f32 v74, v36, v37
    v_cvt_pk_bf16_f32 v75, v38, v39
    v_cvt_pk_bf16_f32 v76, v40, v41
    v_cvt_pk_bf16_f32 v77, v42, v43
    v_cvt_pk_bf16_f32 v78, v44, v45
    v_cvt_pk_bf16_f32 v79, v46, v47
    v_cvt_pk_bf16_f32 v80, v48, v49
    v_pk_mul_f32 v[50:51], v[50:51], v[104:105]
    v_pk_mul_f32 v[52:53], v[52:53], v[104:105]
    v_pk_mul_f32 v[54:55], v[54:55], v[104:105]
    v_pk_mul_f32 v[56:57], v[56:57], v[104:105]
    v_pk_mul_f32 v[58:59], v[58:59], v[104:105]
    v_pk_mul_f32 v[60:61], v[60:61], v[104:105]
    v_pk_mul_f32 v[62:63], v[62:63], v[104:105]
    v_pk_mul_f32 v[64:65], v[64:65], v[104:105]
    v_pk_mul_f32 v[66:67], v[66:67], v[104:105]
    v_cvt_pk_bf16_f32 v84, v50, v51
    v_cvt_pk_bf16_f32 v85, v52, v53
    v_cvt_pk_bf16_f32 v86, v54, v55
    v_cvt_pk_bf16_f32 v87, v56, v57
    v_cvt_pk_bf16_f32 v88, v58, v59
    v_cvt_pk_bf16_f32 v89, v60, v61
    v_cvt_pk_bf16_f32 v90, v62, v63
    v_cvt_pk_bf16_f32 v91, v64, v65
    v_cvt_pk_bf16_f32 v92, v66, v67
    s_mov_b32 s70, 0
L_kvr:
    s_waitcnt vmcnt(14)
    v_mfma_f32_16x16x32_bf16 v[40:43], v[176:179], v[112:115], 0
    v_mfma_f32_16x16x32_bf16 v[40:43], v[180:183], v[116:119], v[40:43]
    s_waitcnt vmcnt(12)
    v_mfma_f32_16x16x32_bf16 v[44:47], v[176:179], v[120:123], 0
    v_mfma_f32_16x16x32_bf16 v[44:47], v[180:183], v[124:127], v[44:47]
    s_waitcnt vmcnt(10)
    v_mfma_f32_16x16x32_bf16 v[40:43], v[176:179], v[128:131], v[40:43]
    v_mfma_f32_16x16x32_bf16 v[40:43], v[180:183], v[132:135], v[40:43]
    s_waitcnt vmcnt(8)
    v_mfma_f32_16x16x32_bf16 v[44:47], v[176:179], v[136:139], v[44:47]
    v_mfma_f32_16x16x32_bf16 v[44:47], v[180:183], v[140:143], v[44:47]
    s_waitcnt vmcnt(6)
    v_mfma_f32_16x16x32_bf16 v[40:43], v[176:179], v[144:147], v[40:43]
    v_mfma_f32_16x16x32_bf16 v[40:43], v[180:183], v[148:151], v[40:43]
    s_waitcnt vmcnt(4)
    v_mfma_f32_16x16x32_bf16 v[44:47], v[176:179], v[152:155], v[44:47]
    v_mfma_f32_16x16x32_bf16 v[44:47], v[180:183], v[156:159], v[44:47]
    s_waitcnt vmcnt(2)
    v_mfma_f32_16x16x32_bf16 v[40:43], v[176:179], v[160:163], v[40:43]
    v_mfma_f32_16x16x32_bf16 v[40:43], v[180:183], v[164:167], v[40:43]
    s_waitcnt vmcnt(0)
    v_mfma_f32_16x16x32_bf16 v[44:47], v[176:179], v[168:171], v[44:47]
    v_mfma_f32_16x16x32_bf16 v[44:47], v[180:183], v[172:175], v[44:47]
    s_add_u32 s70, s70, 1
    s_cmp_gt_u32 s70, 6250
    s_nop 2
    v_cvt_pk_bf16_f32 v48, v40, v41
    v_cvt_pk_bf16_f32 v49, v42, v43
    s_nop 0
    v_cvt_pk_bf16_f32 v50, v44, v45
    v_cvt_pk_bf16_f32 v51, v46, v47
    v_add_f32 v52, v40, v44
    v_cmp_u_f32 vcc, v52, v52
    s_cbranch_scc1 L_kvrx
    s_cbranch_vccz L_kvrx
    v_max_u32 v52, v112, v113
    v_max3_u32 v52, v52, v114, v115
    v_max3_u32 v52, v52, v116, v117
    v_max3_u32 v52, v52, v118, v119
    v_max3_u32 v52, v52, v120, v121
    v_max3_u32 v52, v52, v122, v123
    v_max3_u32 v52, v52, v124, v125
    v_max3_u32 v52, v52, v126, v127
    v_max3_u32 v52, v52, v128, v129
    v_max3_u32 v52, v52, v130, v131
    v_max3_u32 v52, v52, v132, v133
    v_max3_u32 v52, v52, v134, v135
    v_max3_u32 v52, v52, v136, v137
    v_max3_u32 v52, v52, v138, v139
    v_max3_u32 v52, v52, v140, v141
    v_max3_u32 v52, v52, v142, v143
    v_max3_u32 v52, v52, v144, v145
    v_max3_u32 v52, v52, v146, v147
    v_max3_u32 v52, v52, v148, v149
    v_max3_u32 v52, v52, v150, v151
    v_max3_u32 v52, v52, v152, v153
    v_max3_u32 v52, v52, v154, v155
    v_max3_u32 v52, v52, v156, v157
    v_max3_u32 v52, v52, v158, v159
    v_max3_u32 v52, v52, v160, v161
    v_max3_u32 v52, v52, v162, v163
    v_max3_u32 v52, v52, v164, v165
    v_max3_u32 v52, v52, v166, v167
    v_max3_u32 v52, v52, v168, v169
    v_max3_u32 v52, v52, v170, v171
    v_max3_u32 v52, v52, v172, v173
    v_max3_u32 v52, v52, v174, v175
    v_cmp_eq_u32 vcc, -1, v52
    s_cbranch_vccz L_kvrx
    s_sleep 4
    s_mov_b32 s62, 0
    buffer_load_dwordx4 v[112:115], v68, s[40:43], s62 offen offset:0 sc1
    buffer_load_dwordx4 v[116:119], v69, s[40:43], s62 offen offset:256 sc1
    buffer_load_dwordx4 v[120:123], v69, s[40:43], s62 offen offset:512 sc1
    buffer_load_dwordx4 v[124:127], v69, s[40:43], s62 offen offset:768 sc1
    s_mov_b32 s62, 12800
    buffer_load_dwordx4 v[128:131], v68, s[40:43], s62 offen offset:0 sc1
    buffer_load_dwordx4 v[132:135], v69, s[40:43], s62 offen offset:256 sc1
    buffer_load_dwordx4 v[136:139], v69, s[40:43], s62 offen offset:512 sc1
    buffer_load_dwordx4 v[140:143], v69, s[40:43], s62 offen offset:768 sc1
    s_mov_b32 s62, 25600
    buffer_load_dwordx4 v[144:147], v68, s[40:43], s62 offen offset:0 sc1
    buffer_load_dwordx4 v[148:151], v69, s[40:43], s62 offen offset:256 sc1
    buffer_load_dwordx4 v[152:155], v69, s[40:43], s62 offen offset:512 sc1
    buffer_load_dwordx4 v[156:159], v69, s[40:43], s62 offen offset:768 sc1
    s_mov_b32 s62, 38400
    buffer_load_dwordx4 v[160:163], v68, s[40:43], s62 offen offset:0 sc1
    buffer_load_dwordx4 v[164:167], v69, s[40:43], s62 offen offset:256 sc1
    buffer_load_dwordx4 v[168:171], v69, s[40:43], s62 offen offset:512 sc1
    buffer_load_dwordx4 v[172:175], v69, s[40:43], s62 offen offset:768 sc1
    s_branch L_kvr
L_kvrx:
    ds_write_b64 v70, v[48:49]
    ds_write_b64 v70, v[50:51] offset:512
    v_mov_b32 v28, 7
    ds_write_b32 v19, v28
    s_mov_b32 s59, 0
Lw_23:
    ds_read_b128 v[24:27], v18 offset:0
    s_add_u32 s59, s59, 1
    s_waitcnt lgkmcnt(0)
    v_min_u32 v24, v24, v25
    v_min3_u32 v24, v24, v26, v27
    v_cmp_gt_u32 vcc, 7, v24
    s_cmp_gt_u32 s59, 1000000
    s_cbranch_scc1 Lx_24
    s_cbranch_vccnz Lw_23
Lx_24:
    ds_read2_b64 v[32:35], v9 offset0:0 offset1:16
    ds_read2_b64 v[36:39], v9 offset0:4 offset1:20
    ds_read2_b64 v[40:43], v10 offset0:0 offset1:4
    ds_read2_b64 v[44:47], v9 offset0:32 offset1:48
    ds_read2_b64 v[48:51], v9 offset0:36 offset1:52
    ds_read2_b64 v[52:55], v10 offset0:8 offset1:12
    ds_read2_b64 v[56:59], v9 offset0:64 offset1:80
    ds_read2_b64 v[60:63], v9 offset0:68 offset1:84
    ds_read2_b64 v[64:67], v10 offset0:16 offset1:20
    v_mov_b32 v28, 8
    ds_write_b32 v19, v28
    s_waitcnt lgkmcnt(7)
    v_mfma_f32_16x16x32_bf16 v[120:123], v[40:43], v[72:75], 0
    v_mfma_f32_16x16x32_bf16 v[132:135], v[40:43], v[84:87], 0
    v_mfma_f32_16x16x32_bf16 v[112:115], v[32:35], v[72:75], 0
    v_mfma_f32_16x16x32_bf16 v[124:127], v[32:35], v[84:87], 0
    v_mfma_f32_16x16x32_bf16 v[116:119], v[36:39], v[72:75], 0
    v_mfma_f32_16x16x32_bf16 v[128:131], v[36:39], v[84:87], 0
    s_waitcnt lgkmcnt(4)
    v_mfma_f32_16x16x32_bf16 v[120:123], v[52:55], v[76:79], v[120:123]
    v_mfma_f32_16x16x32_bf16 v[132:135], v[52:55], v[88:91], v[132:135]
    v_mfma_f32_16x16x32_bf16 v[112:115], v[44:47], v[76:79], v[112:115]
    v_mfma_f32_16x16x32_bf16 v[124:127], v[44:47], v[88:91], v[124:127]
    v_mfma_f32_16x16x32_bf16 v[116:119], v[48:51], v[76:79], v[116:119]
    v_mfma_f32_16x16x32_bf16 v[128:131], v[48:51], v[88:91], v[128:131]
    s_waitcnt lgkmcnt(1)
    v_mfma_f32_16x16x32_bf16 v[120:123], v[64:67], v[80:83], v[120:123]
    v_mfma_f32_16x16x32_bf16 v[132:135], v[64:67], v[92:95], v[132:135]
    v_mfma_f32_16x16x32_bf16 v[112:115], v[56:59], v[80:83], v[112:115]
    v_mfma_f32_16x16x32_bf16 v[124:127], v[56:59], v[92:95], v[124:127]
    v_mfma_f32_16x16x32_bf16 v[116:119], v[60:63], v[80:83], v[116:119]
    v_mfma_f32_16x16x32_bf16 v[128:131], v[60:63], v[92:95], v[128:131]
    v_mov_b32 v30, s100
    v_mov_b32 v31, s101
    s_nop 0
    v_add_f32 v122, 0x358637bd, v122
    v_add_f32 v134, 0x358637bd, v134
    v_rcp_f32 v122, v122
    v_rcp_f32 v134, v134
    v_mul_f32 v112, v112, v122
    v_mul_f32 v113, v113, v122
    v_mul_f32 v114, v114, v122
    v_mul_f32 v115, v115, v122
    v_mul_f32 v116, v116, v122
    v_mul_f32 v117, v117, v122
    v_mul_f32 v118, v118, v122
    v_mul_f32 v119, v119, v122
    v_mul_f32 v120, v120, v122
    v_mul_f32 v121, v121, v122
    v_cvt_pk_bf16_f32 v32, v112, v113
    v_cvt_pk_bf16_f32 v33, v114, v115
    v_cvt_pk_bf16_f32 v34, v116, v117
    v_cvt_pk_bf16_f32 v35, v118, v119
    v_cvt_pk_bf16_f32 v40, v120, v121
    buffer_store_dwordx4 v[32:35], v1, s[40:43], s51 offen sc1
    v_mul_f32 v124, v124, v134
    v_mul_f32 v125, v125, v134
    v_mul_f32 v126, v126, v134
    v_mul_f32 v127, v127, v134
    v_mul_f32 v128, v128, v134
    v_mul_f32 v129, v129, v134
    v_mul_f32 v130, v130, v134
    v_mul_f32 v131, v131, v134
    v_mul_f32 v132, v132, v134
    v_mul_f32 v133, v133, v134
    v_cvt_pk_bf16_f32 v36, v124, v125
    v_cvt_pk_bf16_f32 v37, v126, v127
    v_cvt_pk_bf16_f32 v38, v128, v129
    v_cvt_pk_bf16_f32 v39, v130, v131
    v_cvt_pk_bf16_f32 v41, v132, v133
    buffer_store_dwordx4 v[36:39], v1, s[40:43], s52 offen sc1
    s_nop 0
    v_permlane32_swap_b32 v40, v41
    s_mov_b32 exec_lo, 0xffff
    s_mov_b32 exec_hi, 0xffff
    buffer_store_dwordx2 v[40:41], v11, s[40:43], s15 offen sc1
    s_mov_b64 exec, -1
    s_add_u32 m0, s58, 32768
    s_add_u32 s53, s57, 32768
    buffer_load_dwordx4 v1, s[40:43], s53 offen offset:0 sc1 lds
    buffer_load_dwordx4 v1, s[40:43], s53 offen offset:1024 sc1 lds
    buffer_load_dwordx4 v1, s[40:43], s53 offen offset:2048 sc1 lds
    buffer_load_dwordx4 v1, s[40:43], s53 offen offset:3072 sc1 lds
    s_mov_b64 exec, 0xff
    s_waitcnt vmcnt(4)
    buffer_store_dwordx2 v[30:31], v22, s[40:43], s54 offen sc1
    s_mov_b64 exec, -1
    s_waitcnt vmcnt(1)
    v_mov_b32 v28, 9
    ds_write_b32 v19, v28
    s_mov_b32 s59, 0
    s_branch Le_28
Lw_26:
    s_sleep 1
Le_28:
    ds_read_b128 v[24:27], v18 offset:16
    s_add_u32 s59, s59, 1
    s_waitcnt lgkmcnt(0)
    v_min_u32 v24, v24, v25
    v_min3_u32 v24, v24, v26, v27
    v_cmp_gt_u32 vcc, 4, v24
    s_cmp_gt_u32 s59, 1000000
    s_cbranch_scc1 Lx_27
    s_cbranch_vccnz Lw_26
Lx_27:
    s_mov_b32 s59, 0
Lw_29:
    ds_read_b128 v[24:27], v18 offset:0
    s_add_u32 s59, s59, 1
    s_waitcnt lgkmcnt(0)
    v_min_u32 v24, v24, v25
    v_min3_u32 v24, v24, v26, v27
    v_cmp_gt_u32 vcc, 9, v24
    s_cmp_gt_u32 s59, 1000000
    s_cbranch_scc1 Lx_30
    s_cbranch_vccnz Lw_29
Lx_30:
    ds_read_b128 v[52:55], v1 offset:0
    ds_read_b128 v[56:59], v1 offset:1024
    ds_read_b128 v[60:63], v1 offset:2048
    ds_read_b128 v[64:67], v1 offset:3072
    ds_read_b128 v[68:71], v12 offset:0
    ds_read_b128 v[92:95], v1 offset:4608
    ds_read_b128 v[96:99], v1 offset:5632
    ds_read_b128 v[100:103], v1 offset:6656
    ds_read_b128 v[104:107], v1 offset:7680
    ds_read_b128 v[108:111], v12 offset:4608
    ds_read_b128 v[184:187], v1 offset:9216
    ds_read_b128 v[188:191], v1 offset:10240
    ds_read_b128 v[192:195], v1 offset:11264
    ds_read_b128 v[196:199], v1 offset:12288
    ds_read_b128 v[200:203], v12 offset:9216
    ds_read_b128 v[204:207], v1 offset:13824
    ds_read_b128 v[208:211], v1 offset:14848
    ds_read_b128 v[212:215], v1 offset:15872
    ds_read_b128 v[216:219], v1 offset:16896
    ds_read_b128 v[220:223], v12 offset:13824
    ds_read_b128 v[224:227], v1 offset:18432
    ds_read_b128 v[228:231], v1 offset:19456
    ds_read_b128 v[232:235], v1 offset:20480
    ds_read_b128 v[236:239], v1 offset:21504
    ds_read_b128 v[240:243], v12 offset:18432
    v_mov_b32 v28, 10
    ds_write_b32 v19, v28
    s_mov_b32 s59, 0
    s_branch Lv_34
Ls_32:
    s_sleep 2
Lv_34:
    s_load_dwordx16 s[16:31], s[12:13], 0 glc
    s_load_dwordx16 s[60:75], s[12:13], 64 glc
    s_add_u32 s59, s59, 1
    s_cmp_gt_u32 s59, 100000
    s_cbranch_scc1 Lt_33
    s_waitcnt lgkmcnt(0)
    s_xor_b64 s[16:17], s[16:17], s[100:101]
    s_xor_b64 s[18:19], s[18:19], s[100:101]
    s_xor_b64 s[20:21], s[20:21], s[100:101]
    s_xor_b64 s[22:23], s[22:23], s[100:101]
    s_xor_b64 s[24:25], s[24:25], s[100:101]
    s_xor_b64 s[26:27], s[26:27], s[100:101]
    s_xor_b64 s[28:29], s[28:29], s[100:101]
    s_xor_b64 s[30:31], s[30:31], s[100:101]
    s_xor_b64 s[60:61], s[60:61], s[100:101]
    s_xor_b64 s[62:63], s[62:63], s[100:101]
    s_xor_b64 s[64:65], s[64:65], s[100:101]
    s_xor_b64 s[66:67], s[66:67], s[100:101]
    s_xor_b64 s[68:69], s[68:69], s[100:101]
    s_xor_b64 s[70:71], s[70:71], s[100:101]
    s_xor_b64 s[72:73], s[72:73], s[100:101]
    s_xor_b64 s[74:75], s[74:75], s[100:101]
    s_or_b64 s[16:17], s[16:17], s[18:19]
    s_or_b64 s[16:17], s[16:17], s[20:21]
    s_or_b64 s[16:17], s[16:17], s[22:23]
    s_or_b64 s[16:17], s[16:17], s[24:25]
    s_or_b64 s[16:17], s[16:17], s[26:27]
    s_or_b64 s[16:17], s[16:17], s[28:29]
    s_or_b64 s[16:17], s[16:17], s[30:31]
    s_or_b64 s[16:17], s[16:17], s[60:61]
    s_or_b64 s[16:17], s[16:17], s[62:63]
    s_or_b64 s[16:17], s[16:17], s[64:65]
    s_or_b64 s[16:17], s[16:17], s[66:67]
    s_or_b64 s[16:17], s[16:17], s[68:69]
    s_or_b64 s[16:17], s[16:17], s[70:71]
    s_or_b64 s[16:17], s[16:17], s[72:73]
    s_or_b64 s[16:17], s[16:17], s[74:75]
    s_cbranch_scc1 Ls_32
Lt_33:
    s_waitcnt lgkmcnt(0)
    buffer_load_dwordx4 v[112:115], v1, s[40:43], s56 offen offset:0 sc1
    buffer_load_dwordx4 v[116:119], v1, s[40:43], s56 offen offset:1024 sc1
    buffer_load_dwordx4 v[120:123], v1, s[40:43], s56 offen offset:2048 sc1
    buffer_load_dwordx4 v[124:127], v1, s[40:43], s56 offen offset:3072 sc1
    s_add_u32 s56, s56, 4096
    buffer_load_dwordx4 v[128:131], v1, s[40:43], s56 offen offset:0 sc1
    buffer_load_dwordx4 v[132:135], v1, s[40:43], s56 offen offset:1024 sc1
    buffer_load_dwordx4 v[136:139], v1, s[40:43], s56 offen offset:2048 sc1
    buffer_load_dwordx4 v[140:143], v1, s[40:43], s56 offen offset:3072 sc1
    s_add_u32 s56, s56, 4096
    buffer_load_dwordx4 v[144:147], v1, s[40:43], s56 offen offset:0 sc1
    s_mov_b32 s59, 0
Lw_35:
    ds_read_b128 v[24:27], v18 offset:0
    s_add_u32 s59, s59, 1
    s_waitcnt lgkmcnt(0)
    v_min_u32 v24, v24, v25
    v_min3_u32 v24, v24, v26, v27
    v_cmp_gt_u32 vcc, 10, v24
    s_cmp_gt_u32 s59, 1000000
    s_cbranch_scc1 Lx_36
    s_cbranch_vccnz Lw_35
Lx_36:
    s_waitcnt vmcnt(8) lgkmcnt(15)
    v_mfma_f32_16x16x32_bf16 v[72:75], v[52:55], v[112:115], 0
    v_mfma_f32_16x16x32_bf16 v[76:79], v[56:59], v[112:115], 0
    v_mfma_f32_16x16x32_bf16 v[80:83], v[60:63], v[112:115], 0
    v_mfma_f32_16x16x32_bf16 v[84:87], v[64:67], v[112:115], 0
    v_mfma_f32_16x16x32_bf16 v[88:91], v[68:71], v[112:115], 0
    buffer_load_dwordx4 v[148:151], v1, s[40:43], s56 offen offset:1024 sc1
    ds_read_b128 v[52:55], v1 offset:23040
    ds_read_b128 v[56:59], v1 offset:24064
    ds_read_b128 v[60:63], v1 offset:25088
    ds_read_b128 v[64:67], v1 offset:26112
    ds_read_b128 v[68:71], v12 offset:23040
    s_waitcnt vmcnt(8) lgkmcnt(15)
    v_mfma_f32_16x16x32_bf16 v[72:75], v[92:95], v[116:119], v[72:75]
    v_mfma_f32_16x16x32_bf16 v[76:79], v[96:99], v[116:119], v[76:79]
    v_mfma_f32_16x16x32_bf16 v[80:83], v[100:103], v[116:119], v[80:83]
    v_mfma_f32_16x16x32_bf16 v[84:87], v[104:107], v[116:119], v[84:87]
    v_mfma_f32_16x16x32_bf16 v[88:91], v[108:111], v[116:119], v[88:91]
    buffer_load_dwordx4 v[152:155], v1, s[40:43], s56 offen offset:2048 sc1
    ds_read_b128 v[92:95], v1 offset:27648
    ds_read_b128 v[96:99], v1 offset:28672
    ds_read_b128 v[100:103], v1 offset:29696
    ds_read_b128 v[104:107], v1 offset:30720
    ds_read_b128 v[108:111], v12 offset:27648
    s_waitcnt vmcnt(8) lgkmcnt(15)
    v_mfma_f32_16x16x32_bf16 v[72:75], v[184:187], v[120:123], v[72:75]
    v_mfma_f32_16x16x32_bf16 v[76:79], v[188:191], v[120:123], v[76:79]
    v_mfma_f32_16x16x32_bf16 v[80:83], v[192:195], v[120:123], v[80:83]
    v_mfma_f32_16x16x32_bf16 v[84:87], v[196:199], v[120:123], v[84:87]
    v_mfma_f32_16x16x32_bf16 v[88:91], v[200:203], v[120:123], v[88:91]
    buffer_load_dwordx4 v[156:159], v1, s[40:43], s56 offen offset:3072 sc1
    ds_read_b128 v[184:187], v1 offset:32256
    ds_read_b128 v[188:191], v1 offset:33280
    ds_read_b128 v[192:195], v1 offset:34304
    ds_read_b128 v[196:199], v1 offset:35328
    ds_read_b128 v[200:203], v12 offset:32256
    s_waitcnt vmcnt(8) lgkmcnt(15)
    v_mfma_f32_16x16x32_bf16 v[72:75], v[204:207], v[124:127], v[72:75]
    v_mfma_f32_16x16x32_bf16 v[76:79], v[208:211], v[124:127], v[76:79]
    v_mfma_f32_16x16x32_bf16 v[80:83], v[212:215], v[124:127], v[80:83]
    v_mfma_f32_16x16x32_bf16 v[84:87], v[216:219], v[124:127], v[84:87]
    v_mfma_f32_16x16x32_bf16 v[88:91], v[220:223], v[124:127], v[88:91]
    s_add_u32 s56, s56, 4096
    buffer_load_dwordx4 v[160:163], v1, s[40:43], s56 offen offset:0 sc1
    ds_read_b128 v[204:207], v1 offset:36864
    ds_read_b128 v[208:211], v1 offset:37888
    ds_read_b128 v[212:215], v1 offset:38912
    ds_read_b128 v[216:219], v1 offset:39936
    ds_read_b128 v[220:223], v12 offset:36864
    s_waitcnt vmcnt(8) lgkmcnt(15)
    v_mfma_f32_16x16x32_bf16 v[72:75], v[224:227], v[128:131], v[72:75]
    v_mfma_f32_16x16x32_bf16 v[76:79], v[228:231], v[128:131], v[76:79]
    v_mfma_f32_16x16x32_bf16 v[80:83], v[232:235], v[128:131], v[80:83]
    v_mfma_f32_16x16x32_bf16 v[84:87], v[236:239], v[128:131], v[84:87]
    v_mfma_f32_16x16x32_bf16 v[88:91], v[240:243], v[128:131], v[88:91]
    buffer_load_dwordx4 v[164:167], v1, s[40:43], s56 offen offset:1024 sc1
    ds_read_b128 v[224:227], v7 offset:0
    ds_read_b128 v[228:231], v7 offset:1024
    ds_read_b128 v[232:235], v7 offset:2048
    ds_read_b128 v[236:239], v7 offset:3072
    ds_read_b128 v[240:243], v13 offset:0
    s_waitcnt vmcnt(8) lgkmcnt(15)
    v_mfma_f32_16x16x32_bf16 v[72:75], v[52:55], v[132:135], v[72:75]
    v_mfma_f32_16x16x32_bf16 v[76:79], v[56:59], v[132:135], v[76:79]
    v_mfma_f32_16x16x32_bf16 v[80:83], v[60:63], v[132:135], v[80:83]
    v_mfma_f32_16x16x32_bf16 v[84:87], v[64:67], v[132:135], v[84:87]
    v_mfma_f32_16x16x32_bf16 v[88:91], v[68:71], v[132:135], v[88:91]
    buffer_load_dwordx4 v[168:171], v1, s[40:43], s56 offen offset:2048 sc1
    ds_read_b128 v[52:55], v7 offset:4608
    ds_read_b128 v[56:59], v7 offset:5632
    ds_read_b128 v[60:63], v7 offset:6656
    ds_read_b128 v[64:67], v7 offset:7680
    ds_read_b128 v[68:71], v13 offset:4608
    s_waitcnt vmcnt(8) lgkmcnt(15)
    v_mfma_f32_16x16x32_bf16 v[72:75], v[92:95], v[136:139], v[72:75]
    v_mfma_f32_16x16x32_bf16 v[76:79], v[96:99], v[136:139], v[76:79]
    v_mfma_f32_16x16x32_bf16 v[80:83], v[100:103], v[136:139], v[80:83]
    v_mfma_f32_16x16x32_bf16 v[84:87], v[104:107], v[136:139], v[84:87]
    v_mfma_f32_16x16x32_bf16 v[88:91], v[108:111], v[136:139], v[88:91]
    buffer_load_dwordx4 v[172:175], v1, s[40:43], s56 offen offset:3072 sc1
    ds_read_b128 v[92:95], v7 offset:9216
    ds_read_b128 v[96:99], v7 offset:10240
    ds_read_b128 v[100:103], v7 offset:11264
    ds_read_b128 v[104:107], v7 offset:12288
    ds_read_b128 v[108:111], v13 offset:9216
    s_waitcnt vmcnt(8) lgkmcnt(15)
    v_mfma_f32_16x16x32_bf16 v[72:75], v[184:187], v[140:143], v[72:75]
    v_mfma_f32_16x16x32_bf16 v[76:79], v[188:191], v[140:143], v[76:79]
    v_mfma_f32_16x16x32_bf16 v[80:83], v[192:195], v[140:143], v[80:83]
    v_mfma_f32_16x16x32_bf16 v[84:87], v[196:199], v[140:143], v[84:87]
    v_mfma_f32_16x16x32_bf16 v[88:91], v[200:203], v[140:143], v[88:91]
    s_add_u32 s56, s56, 4096
    buffer_load_dwordx2 v[176:177], v8, s[40:43], s56 offen offset:0 sc1
    buffer_load_dwordx2 v[178:179], v8, s[40:43], s56 offen offset:512 sc1
    ds_read_b128 v[184:187], v7 offset:13824
    ds_read_b128 v[188:191], v7 offset:14848
    ds_read_b128 v[192:195], v7 offset:15872
    ds_read_b128 v[196:199], v7 offset:16896
    ds_read_b128 v[200:203], v13 offset:13824
    s_waitcnt vmcnt(9) lgkmcnt(15)
    v_mfma_f32_16x16x32_bf16 v[72:75], v[204:207], v[144:147], v[72:75]
    v_mfma_f32_16x16x32_bf16 v[76:79], v[208:211], v[144:147], v[76:79]
    v_mfma_f32_16x16x32_bf16 v[80:83], v[212:215], v[144:147], v[80:83]
    v_mfma_f32_16x16x32_bf16 v[84:87], v[216:219], v[144:147], v[84:87]
    v_mfma_f32_16x16x32_bf16 v[88:91], v[220:223], v[144:147], v[88:91]
    buffer_load_dwordx2 v[180:181], v8, s[40:43], s56 offen offset:1024 sc1
    buffer_load_dwordx2 v[182:183], v8, s[40:43], s56 offen offset:1536 sc1
    ds_read_b128 v[204:207], v7 offset:18432
    ds_read_b128 v[208:211], v7 offset:19456
    ds_read_b128 v[212:215], v7 offset:20480
    ds_read_b128 v[216:219], v7 offset:21504
    ds_read_b128 v[220:223], v13 offset:18432
    s_waitcnt vmcnt(10) lgkmcnt(15)
    v_mfma_f32_16x16x32_bf16 v[72:75], v[224:227], v[148:151], v[72:75]
    v_mfma_f32_16x16x32_bf16 v[76:79], v[228:231], v[148:151], v[76:79]
    v_mfma_f32_16x16x32_bf16 v[80:83], v[232:235], v[148:151], v[80:83]
    v_mfma_f32_16x16x32_bf16 v[84:87], v[236:239], v[148:151], v[84:87]
    v_mfma_f32_16x16x32_bf16 v[88:91], v[240:243], v[148:151], v[88:91]
    ds_read_b128 v[224:227], v7 offset:23040
    ds_read_b128 v[228:231], v7 offset:24064
    ds_read_b128 v[232:235], v7 offset:25088
    ds_read_b128 v[236:239], v7 offset:26112
    ds_read_b128 v[240:243], v13 offset:23040
    s_waitcnt vmcnt(9) lgkmcnt(15)
    v_mfma_f32_16x16x32_bf16 v[72:75], v[52:55], v[152:155], v[72:75]
    v_mfma_f32_16x16x32_bf16 v[76:79], v[56:59], v[152:155], v[76:79]
    v_mfma_f32_16x16x32_bf16 v[80:83], v[60:63], v[152:155], v[80:83]
    v_mfma_f32_16x16x32_bf16 v[84:87], v[64:67], v[152:155], v[84:87]
    v_mfma_f32_16x16x32_bf16 v[88:91], v[68:71], v[152:155], v[88:91]
    ds_read_b128 v[52:55], v7 offset:27648
    ds_read_b128 v[56:59], v7 offset:28672
    ds_read_b128 v[60:63], v7 offset:29696
    ds_read_b128 v[64:67], v7 offset:30720
    ds_read_b128 v[68:71], v13 offset:27648
    s_waitcnt vmcnt(8) lgkmcnt(15)
    v_mfma_f32_16x16x32_bf16 v[72:75], v[92:95], v[156:159], v[72:75]
    v_mfma_f32_16x16x32_bf16 v[76:79], v[96:99], v[156:159], v[76:79]
    v_mfma_f32_16x16x32_bf16 v[80:83], v[100:103], v[156:159], v[80:83]
    v_mfma_f32_16x16x32_bf16 v[84:87], v[104:107], v[156:159], v[84:87]
    v_mfma_f32_16x16x32_bf16 v[88:91], v[108:111], v[156:159], v[88:91]
    ds_read_b128 v[92:95], v7 offset:32256
    ds_read_b128 v[96:99], v7 offset:33280
    ds_read_b128 v[100:103], v7 offset:34304
    ds_read_b128 v[104:107], v7 offset:35328
    ds_read_b128 v[108:111], v13 offset:32256
    s_waitcnt vmcnt(7) lgkmcnt(15)
    v_mfma_f32_16x16x32_bf16 v[72:75], v[184:187], v[160:163], v[72:75]
    v_mfma_f32_16x16x32_bf16 v[76:79], v[188:191], v[160:163], v[76:79]
    v_mfma_f32_16x16x32_bf16 v[80:83], v[192:195], v[160:163], v[80:83]
    v_mfma_f32_16x16x32_bf16 v[84:87], v[196:199], v[160:163], v[84:87]
    v_mfma_f32_16x16x32_bf16 v[88:91], v[200:203], v[160:163], v[88:91]
    ds_read_b128 v[184:187], v7 offset:36864
    ds_read_b128 v[188:191], v7 offset:37888
    ds_read_b128 v[192:195], v7 offset:38912
    ds_read_b128 v[196:199], v7 offset:39936
    ds_read_b128 v[200:203], v13 offset:36864
    s_waitcnt vmcnt(6) lgkmcnt(15)
    v_mfma_f32_16x16x32_bf16 v[72:75], v[204:207], v[164:167], v[72:75]
    v_mfma_f32_16x16x32_bf16 v[76:79], v[208:211], v[164:167], v[76:79]
    v_mfma_f32_16x16x32_bf16 v[80:83], v[212:215], v[164:167], v[80:83]
    v_mfma_f32_16x16x32_bf16 v[84:87], v[216:219], v[164:167], v[84:87]
    v_mfma_f32_16x16x32_bf16 v[88:91], v[220:223], v[164:167], v[88:91]
    s_waitcnt vmcnt(5) lgkmcnt(15)
    v_mfma_f32_16x16x32_bf16 v[72:75], v[224:227], v[168:171], v[72:75]
    v_mfma_f32_16x16x32_bf16 v[76:79], v[228:231], v[168:171], v[76:79]
    v_mfma_f32_16x16x32_bf16 v[80:83], v[232:235], v[168:171], v[80:83]
    v_mfma_f32_16x16x32_bf16 v[84:87], v[236:239], v[168:171], v[84:87]
    v_mfma_f32_16x16x32_bf16 v[88:91], v[240:243], v[168:171], v[88:91]
    s_waitcnt vmcnt(4) lgkmcnt(10)
    v_mfma_f32_16x16x32_bf16 v[72:75], v[52:55], v[172:175], v[72:75]
    v_mfma_f32_16x16x32_bf16 v[76:79], v[56:59], v[172:175], v[76:79]
    v_mfma_f32_16x16x32_bf16 v[80:83], v[60:63], v[172:175], v[80:83]
    v_mfma_f32_16x16x32_bf16 v[84:87], v[64:67], v[172:175], v[84:87]
    v_mfma_f32_16x16x32_bf16 v[88:91], v[68:71], v[172:175], v[88:91]
    s_waitcnt vmcnt(2) lgkmcnt(5)
    v_mfma_f32_16x16x32_bf16 v[72:75], v[92:95], v[176:179], v[72:75]
    v_mfma_f32_16x16x32_bf16 v[76:79], v[96:99], v[176:179], v[76:79]
    v_mfma_f32_16x16x32_bf16 v[80:83], v[100:103], v[176:179], v[80:83]
    v_mfma_f32_16x16x32_bf16 v[84:87], v[104:107], v[176:179], v[84:87]
    v_mfma_f32_16x16x32_bf16 v[88:91], v[108:111], v[176:179], v[88:91]
    s_waitcnt vmcnt(0) lgkmcnt(0)
    v_mfma_f32_16x16x32_bf16 v[72:75], v[184:187], v[180:183], v[72:75]
    v_mfma_f32_16x16x32_bf16 v[76:79], v[188:191], v[180:183], v[76:79]
    v_mfma_f32_16x16x32_bf16 v[80:83], v[192:195], v[180:183], v[80:83]
    v_mfma_f32_16x16x32_bf16 v[84:87], v[196:199], v[180:183], v[84:87]
    v_mfma_f32_16x16x32_bf16 v[88:91], v[200:203], v[180:183], v[88:91]
    s_nop 3
    ds_write_b128 v6, v[72:75] offset:0
    ds_write_b128 v6, v[76:79] offset:64
    ds_write_b128 v6, v[80:83] offset:128
    ds_write_b128 v6, v[84:87] offset:192
    s_mov_b32 exec_hi, 0
    ds_write_b128 v6, v[88:91] offset:256
    v_mov_b32 v28, 11
    ds_write_b32 v19, v28
    s_mov_b64 exec, -1
    s_branch L_fin
L_fin:
L_end:
    s_endpgm
    .p2align 8
    .fill 13312, 4, 0xbf800000
.section .rodata,"a"
.p2align 6
.amdhsa_kernel gated_mix__ssm_conv_s5__linear_kernel_hedgehog__prompt_kernel
  .amdhsa_next_free_vgpr 256
  .amdhsa_next_free_sgpr 102
  .amdhsa_accum_offset 256
  .amdhsa_group_segment_fixed_size 0
  .amdhsa_kernarg_size 136
  .amdhsa_user_sgpr_count 2
  .amdhsa_user_sgpr_kernarg_segment_ptr 1
  .amdhsa_system_sgpr_workgroup_id_x 1
  .amdhsa_float_denorm_mode_32 3
.end_amdhsa_kernel
```
